```python
import torch

def _softmax(x, axis=-1):
    return torch.softmax(x, dim=axis)
def _gelu(x):
    return torch.nn.functional.gelu(x, approximate="tanh")
def _silu(x):
    return torch.nn.functional.silu(x)
def _sigmoid(x):
    return torch.sigmoid(x)
def _layernorm(x, axis=-1, eps=1e-5):
    m = x.mean(dim=axis, keepdim=True)
    v = x.var(dim=axis, keepdim=True, unbiased=False)
    return (x - m) / torch.sqrt(v + eps)
def _scatter_add(tgt, idx, src, axis=0):
    return tgt.clone().index_add_(axis, idx, src)
def _segment_sum(src, seg, n):
    out = torch.zeros((n,) + src.shape[1:], dtype=src.dtype)
    return out.index_add_(0, seg, src)
def _pad(x, pw):
    flat = tuple(v for pair in reversed(pw) for v in pair)
    return torch.nn.functional.pad(x, flat)

kernel_name = 'standalone__gqa_softmax__near_ridge'

def setup_inputs():

    _w = (lambda a: (lambda t: t.to(torch.bfloat16) if t.is_floating_point() else t)(torch.as_tensor(a)))
    B, Hq, Hkv, Sq, Sk, D = 8, 32, 8, 80, 1024, 128
    return {
        "q": _w((lambda *s: torch.randn(*s, dtype=torch.bfloat16) * 0.8)(B, Hq, Sq, D)),
        "k": _w((lambda *s: torch.randn(*s, dtype=torch.bfloat16) * 0.8)(B, Hkv, Sk, D)),
        "v": _w((lambda *s: torch.randn(*s, dtype=torch.bfloat16) * 0.05)(B, Hkv, Sk, D)),
    }

def reference(q, k, v):
    B, Hq, Sq, D = q.shape
    Hkv = k.shape[1]
    rep = Hq // Hkv
    k = (lambda x, n, axis: torch.repeat_interleave(x, n, dim=axis))(k, rep, axis=1)
    v = (lambda x, n, axis: torch.repeat_interleave(x, n, dim=axis))(v, rep, axis=1)
    scale = D ** -0.5
    scores = torch.einsum("bhqd,bhkd->bhqk", q, k) * scale
    p = _softmax(scores, axis=-1)
    return torch.einsum("bhqk,bhkd->bhqd", p, v)
```

```asm
; @launch grid=(256,1,1) block=(256,1,1) lds=154112
.amdgcn_target "amdgcn-amd-amdhsa--gfx950"
.text
.globl standalone__gqa_softmax__near_ridge_kernel
.p2align 8
.type standalone__gqa_softmax__near_ridge_kernel,@function
standalone__gqa_softmax__near_ridge_kernel:
    s_cmp_ge_u32 s2, 256
    s_cbranch_scc1 L_END
    s_load_dwordx4 s[4:7], s[0:1], 0
    s_load_dwordx4 s[8:11], s[0:1], 16
    v_lshrrev_b32 v1, 6, v0
    v_and_b32 v2, 63, v0
    v_readfirstlane_b32 s28, v1
    v_and_b32 v3, 15, v2
    v_lshrrev_b32 v4, 4, v2
    s_and_b32 s29, s2, 7
    s_lshl_b32 s29, s29, 3
    s_lshr_b32 s38, s2, 5
    s_add_u32 s29, s29, s38
    s_lshr_b32 s38, s2, 3
    s_and_b32 s38, s38, 3
    s_lshl_b32 s41, s29, 2
    s_add_u32 s41, s41, s38
    s_lshl_b32 s30, s28, 15
    s_lshl_b32 s39, s29, 18
    s_lshl_b32 s40, s28, 16
    s_add_u32 s39, s39, s40
    s_mul_i32 s40, s41, 20480
    s_waitcnt lgkmcnt(0)
    s_add_u32 s12, s4, s40
    s_addc_u32 s13, s5, 0
    s_mov_b32 s14, 20480
    s_mov_b32 s15, 0x00020000
    s_add_u32 s16, s6, s39
    s_addc_u32 s17, s7, 0
    s_mov_b32 s18, 65536
    s_mov_b32 s19, 0x00020000
    s_add_u32 s20, s8, s39
    s_addc_u32 s21, s9, 0
    s_mov_b32 s22, 65536
    s_mov_b32 s23, 0x00020000
    s_add_u32 s24, s10, s40
    s_addc_u32 s25, s11, 0
    s_mov_b32 s26, 20480
    s_mov_b32 s27, 0x00020000
    v_lshlrev_b32 v5, 8, v3
    v_lshl_add_u32 v22, v4, 4, v5
    v_xor_b32 v6, v3, v4
    v_lshlrev_b32 v7, 8, v4
    v_lshl_add_u32 v10, v6, 4, v7
    v_xor_b32 v11, 64, v10
    v_xor_b32 v12, 128, v10
    v_xor_b32 v13, 192, v10
    v_lshl_add_u32 v16, v6, 4, v5
    v_add_u32 v16, s30, v16
    v_xor_b32 v17, 64, v16
    v_xor_b32 v18, 128, v16
    v_xor_b32 v19, 192, v16
    v_bfe_u32 v5, v2, 1, 2
    v_lshlrev_b32 v5, 8, v5
    v_lshrrev_b32 v6, 3, v2
    v_lshl_add_u32 v5, v6, 5, v5
    v_and_b32 v6, 1, v2
    v_lshl_add_u32 v14, v6, 4, v5
    v_xor_b32 v15, 32, v14
    v_lshlrev_b32 v5, 10, v4
    v_and_b32 v6, 1, v4
    v_lshl_add_u32 v5, v6, 7, v5
    v_bfe_u32 v6, v2, 2, 2
    v_lshl_add_u32 v5, v6, 5, v5
    v_and_b32 v6, 3, v2
    v_lshl_add_u32 v5, v6, 3, v5
    v_add_u32 v20, s30, v5
    v_xor_b32 v21, 128, v20
    v_lshlrev_b32 v23, 4, v2
    v_lshlrev_b32 v5, 8, v3
    v_lshl_add_u32 v24, v4, 3, v5
    s_lshr_b32 s38, s41, 2
    s_lshl_b32 s39, s28, 1
    s_add_u32 s38, s38, s39
    s_and_b32 s38, s38, 7
    s_lshl_b32 s31, s38, 13
    s_add_u32 s32, s31, 4096
    s_mov_b32 s33, s31
    s_mov_b32 s34, s32
    s_mov_b32 s36, 0x3e0293ee
    s_mov_b32 s37, 1
    s_mov_b32 s35, 0
    s_add_u32 m0, s30, 0
    s_nop 0
    buffer_load_dwordx4 v10, s[16:19], s31 offen offset:0 nt lds
    buffer_load_dwordx4 v11, s[16:19], s31 offen offset:1024 nt lds
    buffer_load_dwordx4 v12, s[16:19], s31 offen offset:2048 nt lds
    buffer_load_dwordx4 v13, s[16:19], s31 offen offset:3072 nt lds
    s_add_u32 m0, s30, 4096
    s_nop 0
    buffer_load_dwordx4 v10, s[16:19], s32 offen offset:0 nt lds
    buffer_load_dwordx4 v11, s[16:19], s32 offen offset:1024 nt lds
    buffer_load_dwordx4 v12, s[16:19], s32 offen offset:2048 nt lds
    buffer_load_dwordx4 v13, s[16:19], s32 offen offset:3072 nt lds
    s_add_u32 s32, s31, 8192
    s_and_b32 s31, s32, 0xffff
    s_add_u32 s32, s31, 4096
    s_add_u32 s29, s28, 0
    s_and_b32 s29, s29, 3
    s_lshl_b32 s29, s29, 6
    v_xor_b32 v8, s29, v10
    s_mul_i32 s38, s28, 5120
    s_add_u32 s38, s38, 0
    s_add_u32 m0, s38, 133632
    s_nop 0
    buffer_load_dwordx4 v8, s[12:15], s38 offen nt lds
    s_nop 1
    s_add_u32 s29, s28, 1
    s_and_b32 s29, s29, 3
    s_lshl_b32 s29, s29, 6
    v_xor_b32 v8, s29, v10
    s_mul_i32 s38, s28, 5120
    s_add_u32 s38, s38, 1024
    s_add_u32 m0, s38, 133632
    s_nop 0
    buffer_load_dwordx4 v8, s[12:15], s38 offen nt lds
    s_nop 1
    s_add_u32 s29, s28, 2
    s_and_b32 s29, s29, 3
    s_lshl_b32 s29, s29, 6
    v_xor_b32 v8, s29, v10
    s_mul_i32 s38, s28, 5120
    s_add_u32 s38, s38, 2048
    s_add_u32 m0, s38, 133632
    s_nop 0
    buffer_load_dwordx4 v8, s[12:15], s38 offen nt lds
    s_nop 1
    s_add_u32 s29, s28, 3
    s_and_b32 s29, s29, 3
    s_lshl_b32 s29, s29, 6
    v_xor_b32 v8, s29, v10
    s_mul_i32 s38, s28, 5120
    s_add_u32 s38, s38, 3072
    s_add_u32 m0, s38, 133632
    s_nop 0
    buffer_load_dwordx4 v8, s[12:15], s38 offen nt lds
    s_nop 1
    s_add_u32 s29, s28, 4
    s_and_b32 s29, s29, 3
    s_lshl_b32 s29, s29, 6
    v_xor_b32 v8, s29, v10
    s_mul_i32 s38, s28, 5120
    s_add_u32 s38, s38, 4096
    s_add_u32 m0, s38, 133632
    s_nop 0
    buffer_load_dwordx4 v8, s[12:15], s38 offen nt lds
    s_nop 1
    v_accvgpr_write_b32 a0, 0
    v_accvgpr_write_b32 a1, 0
    v_accvgpr_write_b32 a2, 0
    v_accvgpr_write_b32 a3, 0
    v_accvgpr_write_b32 a4, 0
    v_accvgpr_write_b32 a5, 0
    v_accvgpr_write_b32 a6, 0
    v_accvgpr_write_b32 a7, 0
    v_accvgpr_write_b32 a8, 0
    v_accvgpr_write_b32 a9, 0
    v_accvgpr_write_b32 a10, 0
    v_accvgpr_write_b32 a11, 0
    v_accvgpr_write_b32 a12, 0
    v_accvgpr_write_b32 a13, 0
    v_accvgpr_write_b32 a14, 0
    v_accvgpr_write_b32 a15, 0
    v_accvgpr_write_b32 a16, 0
    v_accvgpr_write_b32 a17, 0
    v_accvgpr_write_b32 a18, 0
    v_accvgpr_write_b32 a19, 0
    v_accvgpr_write_b32 a20, 0
    v_accvgpr_write_b32 a21, 0
    v_accvgpr_write_b32 a22, 0
    v_accvgpr_write_b32 a23, 0
    v_accvgpr_write_b32 a24, 0
    v_accvgpr_write_b32 a25, 0
    v_accvgpr_write_b32 a26, 0
    v_accvgpr_write_b32 a27, 0
    v_accvgpr_write_b32 a28, 0
    v_accvgpr_write_b32 a29, 0
    v_accvgpr_write_b32 a30, 0
    v_accvgpr_write_b32 a31, 0
    v_accvgpr_write_b32 a32, 0
    v_accvgpr_write_b32 a33, 0
    v_accvgpr_write_b32 a34, 0
    v_accvgpr_write_b32 a35, 0
    v_accvgpr_write_b32 a36, 0
    v_accvgpr_write_b32 a37, 0
    v_accvgpr_write_b32 a38, 0
    v_accvgpr_write_b32 a39, 0
    v_accvgpr_write_b32 a40, 0
    v_accvgpr_write_b32 a41, 0
    v_accvgpr_write_b32 a42, 0
    v_accvgpr_write_b32 a43, 0
    v_accvgpr_write_b32 a44, 0
    v_accvgpr_write_b32 a45, 0
    v_accvgpr_write_b32 a46, 0
    v_accvgpr_write_b32 a47, 0
    v_accvgpr_write_b32 a48, 0
    v_accvgpr_write_b32 a49, 0
    v_accvgpr_write_b32 a50, 0
    v_accvgpr_write_b32 a51, 0
    v_accvgpr_write_b32 a52, 0
    v_accvgpr_write_b32 a53, 0
    v_accvgpr_write_b32 a54, 0
    v_accvgpr_write_b32 a55, 0
    v_accvgpr_write_b32 a56, 0
    v_accvgpr_write_b32 a57, 0
    v_accvgpr_write_b32 a58, 0
    v_accvgpr_write_b32 a59, 0
    v_accvgpr_write_b32 a60, 0
    v_accvgpr_write_b32 a61, 0
    v_accvgpr_write_b32 a62, 0
    v_accvgpr_write_b32 a63, 0
    v_accvgpr_write_b32 a64, 0
    v_accvgpr_write_b32 a65, 0
    v_accvgpr_write_b32 a66, 0
    v_accvgpr_write_b32 a67, 0
    v_accvgpr_write_b32 a68, 0
    v_accvgpr_write_b32 a69, 0
    v_accvgpr_write_b32 a70, 0
    v_accvgpr_write_b32 a71, 0
    v_accvgpr_write_b32 a72, 0
    v_accvgpr_write_b32 a73, 0
    v_accvgpr_write_b32 a74, 0
    v_accvgpr_write_b32 a75, 0
    v_accvgpr_write_b32 a76, 0
    v_accvgpr_write_b32 a77, 0
    v_accvgpr_write_b32 a78, 0
    v_accvgpr_write_b32 a79, 0
    v_accvgpr_write_b32 a80, 0
    v_accvgpr_write_b32 a81, 0
    v_accvgpr_write_b32 a82, 0
    v_accvgpr_write_b32 a83, 0
    v_accvgpr_write_b32 a84, 0
    v_accvgpr_write_b32 a85, 0
    v_accvgpr_write_b32 a86, 0
    v_accvgpr_write_b32 a87, 0
    v_accvgpr_write_b32 a88, 0
    v_accvgpr_write_b32 a89, 0
    v_accvgpr_write_b32 a90, 0
    v_accvgpr_write_b32 a91, 0
    v_accvgpr_write_b32 a92, 0
    v_accvgpr_write_b32 a93, 0
    v_accvgpr_write_b32 a94, 0
    v_accvgpr_write_b32 a95, 0
    v_accvgpr_write_b32 a96, 0
    v_accvgpr_write_b32 a97, 0
    v_accvgpr_write_b32 a98, 0
    v_accvgpr_write_b32 a99, 0
    v_accvgpr_write_b32 a100, 0
    v_accvgpr_write_b32 a101, 0
    v_accvgpr_write_b32 a102, 0
    v_accvgpr_write_b32 a103, 0
    v_accvgpr_write_b32 a104, 0
    v_accvgpr_write_b32 a105, 0
    v_accvgpr_write_b32 a106, 0
    v_accvgpr_write_b32 a107, 0
    v_accvgpr_write_b32 a108, 0
    v_accvgpr_write_b32 a109, 0
    v_accvgpr_write_b32 a110, 0
    v_accvgpr_write_b32 a111, 0
    v_accvgpr_write_b32 a112, 0
    v_accvgpr_write_b32 a113, 0
    v_accvgpr_write_b32 a114, 0
    v_accvgpr_write_b32 a115, 0
    v_accvgpr_write_b32 a116, 0
    v_accvgpr_write_b32 a117, 0
    v_accvgpr_write_b32 a118, 0
    v_accvgpr_write_b32 a119, 0
    v_accvgpr_write_b32 a120, 0
    v_accvgpr_write_b32 a121, 0
    v_accvgpr_write_b32 a122, 0
    v_accvgpr_write_b32 a123, 0
    v_accvgpr_write_b32 a124, 0
    v_accvgpr_write_b32 a125, 0
    v_accvgpr_write_b32 a126, 0
    v_accvgpr_write_b32 a127, 0
    v_accvgpr_write_b32 a128, 0
    v_accvgpr_write_b32 a129, 0
    v_accvgpr_write_b32 a130, 0
    v_accvgpr_write_b32 a131, 0
    v_accvgpr_write_b32 a132, 0
    v_accvgpr_write_b32 a133, 0
    v_accvgpr_write_b32 a134, 0
    v_accvgpr_write_b32 a135, 0
    v_accvgpr_write_b32 a136, 0
    v_accvgpr_write_b32 a137, 0
    v_accvgpr_write_b32 a138, 0
    v_accvgpr_write_b32 a139, 0
    v_accvgpr_write_b32 a140, 0
    v_accvgpr_write_b32 a141, 0
    v_accvgpr_write_b32 a142, 0
    v_accvgpr_write_b32 a143, 0
    v_accvgpr_write_b32 a144, 0
    v_accvgpr_write_b32 a145, 0
    v_accvgpr_write_b32 a146, 0
    v_accvgpr_write_b32 a147, 0
    v_accvgpr_write_b32 a148, 0
    v_accvgpr_write_b32 a149, 0
    v_accvgpr_write_b32 a150, 0
    v_accvgpr_write_b32 a151, 0
    v_accvgpr_write_b32 a152, 0
    v_accvgpr_write_b32 a153, 0
    v_accvgpr_write_b32 a154, 0
    v_accvgpr_write_b32 a155, 0
    v_accvgpr_write_b32 a156, 0
    v_accvgpr_write_b32 a157, 0
    v_accvgpr_write_b32 a158, 0
    v_accvgpr_write_b32 a159, 0
    v_mov_b32 v68, 0
    v_mov_b32 v69, 0
    v_mov_b32 v70, 0
    v_mov_b32 v71, 0
    v_mov_b32 v72, 0
    v_mov_b32 v73, 0
    v_mov_b32 v74, 0
    v_mov_b32 v75, 0
    v_mov_b32 v76, 0
    v_mov_b32 v77, 0
    v_mov_b32 v78, 0
    v_mov_b32 v79, 0
    v_mov_b32 v80, 0
    v_mov_b32 v81, 0
    v_mov_b32 v82, 0
    v_mov_b32 v83, 0
    v_mov_b32 v84, 0
    v_mov_b32 v85, 0
    v_mov_b32 v86, 0
    v_mov_b32 v87, 0
    v_mov_b32 v120, 0
    v_mov_b32 v121, 0
    v_mov_b32 v122, 0
    v_mov_b32 v123, 0
    v_mov_b32 v124, 0
    v_mov_b32 v125, 0
    v_mov_b32 v126, 0
    v_mov_b32 v127, 0
    v_mov_b32 v128, 0
    v_mov_b32 v129, 0
    v_mov_b32 v130, 0
    v_mov_b32 v131, 0
    v_mov_b32 v132, 0
    v_mov_b32 v133, 0
    v_mov_b32 v134, 0
    v_mov_b32 v135, 0
    v_mov_b32 v136, 0
    v_mov_b32 v137, 0
    v_mov_b32 v138, 0
    v_mov_b32 v139, 0
    v_mov_b32 v140, 0
    v_mov_b32 v141, 0
    v_mov_b32 v142, 0
    v_mov_b32 v143, 0
    v_mov_b32 v144, 0
    v_mov_b32 v145, 0
    v_mov_b32 v146, 0
    v_mov_b32 v147, 0
    v_mov_b32 v148, 0
    v_mov_b32 v149, 0
    v_mov_b32 v150, 0
    v_mov_b32 v151, 0
    v_mov_b32 v60, 0
    v_mov_b32 v61, 0
    v_mov_b32 v62, 0
    v_mov_b32 v63, 0
    v_mov_b32 v64, 0
    v_mov_b32 v65, 0
    v_mov_b32 v66, 0
    v_mov_b32 v67, 0
    v_mov_b32 v40, 0x3f803f80
    v_mov_b32 v41, 0x3f803f80
    v_mov_b32 v42, 0x3f803f80
    v_mov_b32 v43, 0x3f803f80
    v_mov_b32 v25, 0xff800000
    v_mov_b32 v30, 0xff800000
    v_mov_b32 v35, 0
    v_mov_b32 v26, 0xff800000
    v_mov_b32 v31, 0xff800000
    v_mov_b32 v36, 0
    v_mov_b32 v27, 0xff800000
    v_mov_b32 v32, 0xff800000
    v_mov_b32 v37, 0
    v_mov_b32 v28, 0xff800000
    v_mov_b32 v33, 0xff800000
    v_mov_b32 v38, 0
    v_mov_b32 v29, 0xff800000
    v_mov_b32 v34, 0xff800000
    v_mov_b32 v39, 0
    s_add_u32 m0, s30, 16384
    s_nop 0
    buffer_load_dwordx4 v14, s[20:23], s33 offen offset:0 nt lds
    buffer_load_dwordx4 v15, s[20:23], s33 offen offset:1024 nt lds
    buffer_load_dwordx4 v14, s[20:23], s33 offen offset:2048 nt lds
    buffer_load_dwordx4 v15, s[20:23], s33 offen offset:3072 nt lds
    s_add_u32 m0, s30, 20480
    s_nop 0
    buffer_load_dwordx4 v14, s[20:23], s34 offen offset:0 nt lds
    buffer_load_dwordx4 v15, s[20:23], s34 offen offset:1024 nt lds
    buffer_load_dwordx4 v14, s[20:23], s34 offen offset:2048 nt lds
    buffer_load_dwordx4 v15, s[20:23], s34 offen offset:3072 nt lds
    s_add_u32 s34, s33, 8192
    s_and_b32 s33, s34, 0xffff
    s_add_u32 s34, s33, 4096
    s_add_u32 m0, s30, 8192
    s_nop 0
    buffer_load_dwordx4 v10, s[16:19], s31 offen offset:0 nt lds
    buffer_load_dwordx4 v11, s[16:19], s31 offen offset:1024 nt lds
    buffer_load_dwordx4 v12, s[16:19], s31 offen offset:2048 nt lds
    buffer_load_dwordx4 v13, s[16:19], s31 offen offset:3072 nt lds
    s_add_u32 m0, s30, 12288
    s_nop 0
    buffer_load_dwordx4 v10, s[16:19], s32 offen offset:0 nt lds
    buffer_load_dwordx4 v11, s[16:19], s32 offen offset:1024 nt lds
    buffer_load_dwordx4 v12, s[16:19], s32 offen offset:2048 nt lds
    buffer_load_dwordx4 v13, s[16:19], s32 offen offset:3072 nt lds
    s_add_u32 s32, s31, 8192
    s_and_b32 s31, s32, 0xffff
    s_add_u32 s32, s31, 4096
    s_add_u32 m0, s30, 24576
    s_nop 0
    buffer_load_dwordx4 v14, s[20:23], s33 offen offset:0 nt lds
    buffer_load_dwordx4 v15, s[20:23], s33 offen offset:1024 nt lds
    buffer_load_dwordx4 v14, s[20:23], s33 offen offset:2048 nt lds
    buffer_load_dwordx4 v15, s[20:23], s33 offen offset:3072 nt lds
    s_add_u32 m0, s30, 28672
    s_nop 0
    buffer_load_dwordx4 v14, s[20:23], s34 offen offset:0 nt lds
    buffer_load_dwordx4 v15, s[20:23], s34 offen offset:1024 nt lds
    buffer_load_dwordx4 v14, s[20:23], s34 offen offset:2048 nt lds
    buffer_load_dwordx4 v15, s[20:23], s34 offen offset:3072 nt lds
    s_add_u32 s34, s33, 8192
    s_and_b32 s33, s34, 0xffff
    s_add_u32 s34, s33, 4096
    v_subrev_u32 v6, s30, v16
    v_add_u32 v6, 133632, v6
    v_xor_b32 v7, 64, v6
    v_xor_b32 v8, 128, v6
    v_xor_b32 v9, 192, v6
    s_waitcnt vmcnt(24)
    s_barrier
    ds_read_b128 a[160:163], v6 offset:0
    ds_read_b128 a[164:167], v7 offset:0
    ds_read_b128 a[168:171], v8 offset:0
    ds_read_b128 a[172:175], v9 offset:0
    ds_read_b128 a[176:179], v6 offset:4096
    ds_read_b128 a[180:183], v7 offset:4096
    ds_read_b128 a[184:187], v8 offset:4096
    ds_read_b128 a[188:191], v9 offset:4096
    ds_read_b128 a[192:195], v6 offset:8192
    ds_read_b128 a[196:199], v7 offset:8192
    ds_read_b128 a[200:203], v8 offset:8192
    ds_read_b128 a[204:207], v9 offset:8192
    ds_read_b128 a[208:211], v6 offset:12288
    ds_read_b128 a[212:215], v7 offset:12288
    ds_read_b128 a[216:219], v8 offset:12288
    ds_read_b128 a[220:223], v9 offset:12288
    ds_read_b128 a[224:227], v6 offset:16384
    ds_read_b128 a[228:231], v7 offset:16384
    ds_read_b128 a[232:235], v8 offset:16384
    ds_read_b128 a[236:239], v9 offset:16384
    ds_read_b128 v[88:91], v16 offset:0
    ds_read_b128 v[92:95], v17 offset:0
    ds_read_b128 v[96:99], v18 offset:0
    ds_read_b128 v[100:103], v19 offset:0
    ds_read_b128 v[104:107], v16 offset:4096
    ds_read_b128 v[108:111], v17 offset:4096
    ds_read_b128 v[112:115], v18 offset:4096
    ds_read_b128 v[116:119], v19 offset:4096
    s_waitcnt lgkmcnt(0)
    s_add_u32 m0, s30, 0
    s_nop 0
    buffer_load_dwordx4 v10, s[16:19], s31 offen offset:0 nt lds
    buffer_load_dwordx4 v11, s[16:19], s31 offen offset:1024 nt lds
    buffer_load_dwordx4 v12, s[16:19], s31 offen offset:2048 nt lds
    buffer_load_dwordx4 v13, s[16:19], s31 offen offset:3072 nt lds
    s_add_u32 m0, s30, 4096
    s_nop 0
    buffer_load_dwordx4 v10, s[16:19], s32 offen offset:0 nt lds
    buffer_load_dwordx4 v11, s[16:19], s32 offen offset:1024 nt lds
    buffer_load_dwordx4 v12, s[16:19], s32 offen offset:2048 nt lds
    buffer_load_dwordx4 v13, s[16:19], s32 offen offset:3072 nt lds
    s_add_u32 s32, s31, 8192
    s_and_b32 s31, s32, 0xffff
    s_add_u32 s32, s31, 4096
    v_mfma_f32_16x16x32_bf16 v[44:47], v[88:91], a[160:163], 0
    v_mfma_f32_16x16x32_bf16 v[44:47], v[92:95], a[164:167], v[44:47]
    v_mfma_f32_16x16x32_bf16 v[44:47], v[96:99], a[168:171], v[44:47]
    v_mfma_f32_16x16x32_bf16 v[44:47], v[100:103], a[172:175], v[44:47]
    v_mfma_f32_16x16x32_bf16 v[48:51], v[104:107], a[160:163], 0
    v_mfma_f32_16x16x32_bf16 v[48:51], v[108:111], a[164:167], v[48:51]
    v_mfma_f32_16x16x32_bf16 v[48:51], v[112:115], a[168:171], v[48:51]
    v_mfma_f32_16x16x32_bf16 v[48:51], v[116:119], a[172:175], v[48:51]
    s_nop 7
L_LOOP:
    s_waitcnt vmcnt(24)
    v_mfma_f32_16x16x32_bf16 v[52:55], v[88:91], a[176:179], 0
    v_max3_f32 v1, v44, v45, v46
    v_max3_f32 v2, v47, v48, v49
    v_mfma_f32_16x16x32_bf16 v[52:55], v[92:95], a[180:183], v[52:55]
    v_max3_f32 v1, v50, v51, v1
    v_max_f32 v1, v1, v2
    v_mfma_f32_16x16x32_bf16 v[52:55], v[96:99], a[184:187], v[52:55]
    v_cmp_gt_f32 vcc, v1, v30
    s_cbranch_vccnz SLOW_0_0
RET_0_0:
    v_mfma_f32_16x16x32_bf16 v[52:55], v[100:103], a[188:191], v[52:55]
    v_fma_f32 v44, v44, s36, v35
    v_fma_f32 v45, v45, s36, v35
    v_mfma_f32_16x16x32_bf16 v[56:59], v[104:107], a[176:179], 0
    v_fma_f32 v46, v46, s36, v35
    v_fma_f32 v47, v47, s36, v35
    v_mfma_f32_16x16x32_bf16 v[56:59], v[108:111], a[180:183], v[56:59]
    v_fma_f32 v48, v48, s36, v35
    v_fma_f32 v49, v49, s36, v35
    v_mfma_f32_16x16x32_bf16 v[56:59], v[112:115], a[184:187], v[56:59]
    v_fma_f32 v50, v50, s36, v35
    v_fma_f32 v51, v51, s36, v35
    v_mfma_f32_16x16x32_bf16 v[56:59], v[116:119], a[188:191], v[56:59]
    v_exp_f32 v44, v44
    v_mfma_f32_16x16x32_bf16 a[128:131], v[120:123], v[64:67], a[128:131]
    ds_read_b64_tr_b16 v[120:121], v20 offset:16384
    ds_read_b64_tr_b16 v[122:123], v20 offset:20480
    v_exp_f32 v45, v45
    v_mfma_f32_16x16x32_bf16 a[132:135], v[124:127], v[64:67], a[132:135]
    ds_read_b64_tr_b16 v[124:125], v21 offset:16384
    ds_read_b64_tr_b16 v[126:127], v21 offset:20480
    v_exp_f32 v46, v46
    v_mfma_f32_16x16x32_bf16 a[136:139], v[128:131], v[64:67], a[136:139]
    ds_read_b64_tr_b16 v[128:129], v20 offset:16640
    ds_read_b64_tr_b16 v[130:131], v20 offset:20736
    v_exp_f32 v47, v47
    v_mfma_f32_16x16x32_bf16 a[140:143], v[132:135], v[64:67], a[140:143]
    ds_read_b64_tr_b16 v[132:133], v21 offset:16640
    ds_read_b64_tr_b16 v[134:135], v21 offset:20736
    v_exp_f32 v48, v48
    v_mfma_f32_16x16x32_bf16 a[144:147], v[136:139], v[64:67], a[144:147]
    ds_read_b64_tr_b16 v[136:137], v20 offset:16896
    ds_read_b64_tr_b16 v[138:139], v20 offset:20992
    v_exp_f32 v49, v49
    v_mfma_f32_16x16x32_bf16 a[148:151], v[140:143], v[64:67], a[148:151]
    ds_read_b64_tr_b16 v[140:141], v21 offset:16896
    ds_read_b64_tr_b16 v[142:143], v21 offset:20992
    v_exp_f32 v50, v50
    v_mfma_f32_16x16x32_bf16 a[152:155], v[144:147], v[64:67], a[152:155]
    ds_read_b64_tr_b16 v[144:145], v20 offset:17152
    ds_read_b64_tr_b16 v[146:147], v20 offset:21248
    v_exp_f32 v51, v51
    v_mfma_f32_16x16x32_bf16 a[156:159], v[148:151], v[64:67], a[156:159]
    ds_read_b64_tr_b16 v[148:149], v21 offset:17152
    ds_read_b64_tr_b16 v[150:151], v21 offset:21248
    v_cvt_pk_bf16_f32 v60, v44, v45
    v_cvt_pk_bf16_f32 v61, v46, v47
    v_mfma_f32_16x16x32_bf16 v[84:87], v[40:43], v[64:67], v[84:87]
    v_cvt_pk_bf16_f32 v62, v48, v49
    v_cvt_pk_bf16_f32 v63, v50, v51
    s_waitcnt lgkmcnt(0)
    v_mfma_f32_16x16x32_bf16 v[44:47], v[88:91], a[192:195], 0
    s_add_u32 m0, s30, 16384
    v_max3_f32 v1, v52, v53, v54
    v_max3_f32 v2, v55, v56, v57
    v_mfma_f32_16x16x32_bf16 v[44:47], v[92:95], a[196:199], v[44:47]
    buffer_load_dwordx4 v14, s[20:23], s33 offen offset:0 nt lds
    v_max3_f32 v1, v58, v59, v1
    v_max_f32 v1, v1, v2
    v_mfma_f32_16x16x32_bf16 v[44:47], v[96:99], a[200:203], v[44:47]
    buffer_load_dwordx4 v15, s[20:23], s33 offen offset:1024 nt lds
    v_cmp_gt_f32 vcc, v1, v31
    s_cbranch_vccnz SLOW_0_1
RET_0_1:
    v_mfma_f32_16x16x32_bf16 v[44:47], v[100:103], a[204:207], v[44:47]
    buffer_load_dwordx4 v14, s[20:23], s33 offen offset:2048 nt lds
    v_fma_f32 v52, v52, s36, v36
    v_fma_f32 v53, v53, s36, v36
    v_mfma_f32_16x16x32_bf16 v[48:51], v[104:107], a[192:195], 0
    buffer_load_dwordx4 v15, s[20:23], s33 offen offset:3072 nt lds
    v_fma_f32 v54, v54, s36, v36
    v_fma_f32 v55, v55, s36, v36
    v_mfma_f32_16x16x32_bf16 v[48:51], v[108:111], a[196:199], v[48:51]
    s_add_u32 m0, s30, 20480
    v_fma_f32 v56, v56, s36, v36
    v_fma_f32 v57, v57, s36, v36
    v_mfma_f32_16x16x32_bf16 v[48:51], v[112:115], a[200:203], v[48:51]
    buffer_load_dwordx4 v14, s[20:23], s34 offen offset:0 nt lds
    v_fma_f32 v58, v58, s36, v36
    v_fma_f32 v59, v59, s36, v36
    v_mfma_f32_16x16x32_bf16 v[48:51], v[116:119], a[204:207], v[48:51]
    buffer_load_dwordx4 v15, s[20:23], s34 offen offset:1024 nt lds
    v_exp_f32 v52, v52
    v_mfma_f32_16x16x32_bf16 a[0:3], v[120:123], v[60:63], a[0:3]
    buffer_load_dwordx4 v14, s[20:23], s34 offen offset:2048 nt lds
    v_exp_f32 v53, v53
    v_mfma_f32_16x16x32_bf16 a[4:7], v[124:127], v[60:63], a[4:7]
    buffer_load_dwordx4 v15, s[20:23], s34 offen offset:3072 nt lds
    v_exp_f32 v54, v54
    v_mfma_f32_16x16x32_bf16 a[8:11], v[128:131], v[60:63], a[8:11]
    s_add_u32 s34, s33, 8192
    s_and_b32 s33, s34, 0xffff
    s_add_u32 s34, s33, 4096
    v_exp_f32 v55, v55
    v_mfma_f32_16x16x32_bf16 a[12:15], v[132:135], v[60:63], a[12:15]
    v_exp_f32 v56, v56
    v_mfma_f32_16x16x32_bf16 a[16:19], v[136:139], v[60:63], a[16:19]
    v_exp_f32 v57, v57
    v_mfma_f32_16x16x32_bf16 a[20:23], v[140:143], v[60:63], a[20:23]
    v_exp_f32 v58, v58
    v_mfma_f32_16x16x32_bf16 a[24:27], v[144:147], v[60:63], a[24:27]
    v_exp_f32 v59, v59
    v_mfma_f32_16x16x32_bf16 a[28:31], v[148:151], v[60:63], a[28:31]
    v_cvt_pk_bf16_f32 v64, v52, v53
    v_cvt_pk_bf16_f32 v65, v54, v55
    v_mfma_f32_16x16x32_bf16 v[68:71], v[40:43], v[60:63], v[68:71]
    v_cvt_pk_bf16_f32 v66, v56, v57
    v_cvt_pk_bf16_f32 v67, v58, v59
    v_mfma_f32_16x16x32_bf16 v[52:55], v[88:91], a[208:211], 0
    v_max3_f32 v1, v44, v45, v46
    v_max3_f32 v2, v47, v48, v49
    v_mfma_f32_16x16x32_bf16 v[52:55], v[92:95], a[212:215], v[52:55]
    v_max3_f32 v1, v50, v51, v1
    v_max_f32 v1, v1, v2
    v_mfma_f32_16x16x32_bf16 v[52:55], v[96:99], a[216:219], v[52:55]
    v_cmp_gt_f32 vcc, v1, v32
    s_cbranch_vccnz SLOW_0_2
RET_0_2:
    v_mfma_f32_16x16x32_bf16 v[52:55], v[100:103], a[220:223], v[52:55]
    v_fma_f32 v44, v44, s36, v37
    v_fma_f32 v45, v45, s36, v37
    v_mfma_f32_16x16x32_bf16 v[56:59], v[104:107], a[208:211], 0
    v_fma_f32 v46, v46, s36, v37
    v_fma_f32 v47, v47, s36, v37
    v_mfma_f32_16x16x32_bf16 v[56:59], v[108:111], a[212:215], v[56:59]
    v_fma_f32 v48, v48, s36, v37
    v_fma_f32 v49, v49, s36, v37
    v_mfma_f32_16x16x32_bf16 v[56:59], v[112:115], a[216:219], v[56:59]
    v_fma_f32 v50, v50, s36, v37
    v_fma_f32 v51, v51, s36, v37
    v_mfma_f32_16x16x32_bf16 v[56:59], v[116:119], a[220:223], v[56:59]
    v_exp_f32 v44, v44
    v_mfma_f32_16x16x32_bf16 a[32:35], v[120:123], v[64:67], a[32:35]
    v_exp_f32 v45, v45
    v_mfma_f32_16x16x32_bf16 a[36:39], v[124:127], v[64:67], a[36:39]
    v_exp_f32 v46, v46
    v_mfma_f32_16x16x32_bf16 a[40:43], v[128:131], v[64:67], a[40:43]
    v_exp_f32 v47, v47
    v_mfma_f32_16x16x32_bf16 a[44:47], v[132:135], v[64:67], a[44:47]
    v_exp_f32 v48, v48
    v_mfma_f32_16x16x32_bf16 a[48:51], v[136:139], v[64:67], a[48:51]
    v_exp_f32 v49, v49
    v_mfma_f32_16x16x32_bf16 a[52:55], v[140:143], v[64:67], a[52:55]
    v_exp_f32 v50, v50
    v_mfma_f32_16x16x32_bf16 a[56:59], v[144:147], v[64:67], a[56:59]
    v_exp_f32 v51, v51
    v_mfma_f32_16x16x32_bf16 a[60:63], v[148:151], v[64:67], a[60:63]
    v_cvt_pk_bf16_f32 v60, v44, v45
    v_cvt_pk_bf16_f32 v61, v46, v47
    v_mfma_f32_16x16x32_bf16 v[72:75], v[40:43], v[64:67], v[72:75]
    v_cvt_pk_bf16_f32 v62, v48, v49
    v_cvt_pk_bf16_f32 v63, v50, v51
    s_waitcnt vmcnt(24)
    v_mfma_f32_16x16x32_bf16 v[44:47], v[88:91], a[224:227], 0
    ds_read_b128 v[88:91], v16 offset:8192
    v_max3_f32 v1, v52, v53, v54
    v_max3_f32 v2, v55, v56, v57
    v_mfma_f32_16x16x32_bf16 v[44:47], v[92:95], a[228:231], v[44:47]
    ds_read_b128 v[92:95], v17 offset:8192
    v_max3_f32 v1, v58, v59, v1
    v_max_f32 v1, v1, v2
    v_mfma_f32_16x16x32_bf16 v[44:47], v[96:99], a[232:235], v[44:47]
    ds_read_b128 v[96:99], v18 offset:8192
    v_cmp_gt_f32 vcc, v1, v33
    s_cbranch_vccnz SLOW_0_3
RET_0_3:
    v_mfma_f32_16x16x32_bf16 v[44:47], v[100:103], a[236:239], v[44:47]
    ds_read_b128 v[100:103], v19 offset:8192
    v_fma_f32 v52, v52, s36, v38
    v_fma_f32 v53, v53, s36, v38
    v_mfma_f32_16x16x32_bf16 v[48:51], v[104:107], a[224:227], 0
    ds_read_b128 v[104:107], v16 offset:12288
    v_fma_f32 v54, v54, s36, v38
    v_fma_f32 v55, v55, s36, v38
    v_mfma_f32_16x16x32_bf16 v[48:51], v[108:111], a[228:231], v[48:51]
    ds_read_b128 v[108:111], v17 offset:12288
    v_fma_f32 v56, v56, s36, v38
    v_fma_f32 v57, v57, s36, v38
    v_mfma_f32_16x16x32_bf16 v[48:51], v[112:115], a[232:235], v[48:51]
    ds_read_b128 v[112:115], v18 offset:12288
    v_fma_f32 v58, v58, s36, v38
    v_fma_f32 v59, v59, s36, v38
    v_mfma_f32_16x16x32_bf16 v[48:51], v[116:119], a[236:239], v[48:51]
    ds_read_b128 v[116:119], v19 offset:12288
    v_exp_f32 v52, v52
    v_mfma_f32_16x16x32_bf16 a[64:67], v[120:123], v[60:63], a[64:67]
    v_exp_f32 v53, v53
    v_mfma_f32_16x16x32_bf16 a[68:71], v[124:127], v[60:63], a[68:71]
    v_exp_f32 v54, v54
    v_mfma_f32_16x16x32_bf16 a[72:75], v[128:131], v[60:63], a[72:75]
    v_exp_f32 v55, v55
    v_mfma_f32_16x16x32_bf16 a[76:79], v[132:135], v[60:63], a[76:79]
    v_exp_f32 v56, v56
    v_mfma_f32_16x16x32_bf16 a[80:83], v[136:139], v[60:63], a[80:83]
    v_exp_f32 v57, v57
    v_mfma_f32_16x16x32_bf16 a[84:87], v[140:143], v[60:63], a[84:87]
    v_exp_f32 v58, v58
    v_mfma_f32_16x16x32_bf16 a[88:91], v[144:147], v[60:63], a[88:91]
    v_exp_f32 v59, v59
    v_mfma_f32_16x16x32_bf16 a[92:95], v[148:151], v[60:63], a[92:95]
    v_cvt_pk_bf16_f32 v64, v52, v53
    v_cvt_pk_bf16_f32 v65, v54, v55
    v_mfma_f32_16x16x32_bf16 v[76:79], v[40:43], v[60:63], v[76:79]
    v_cvt_pk_bf16_f32 v66, v56, v57
    v_cvt_pk_bf16_f32 v67, v58, v59
    s_waitcnt lgkmcnt(0)
    v_mfma_f32_16x16x32_bf16 v[52:55], v[88:91], a[160:163], 0
    s_add_u32 m0, s30, 8192
    v_max3_f32 v1, v44, v45, v46
    v_max3_f32 v2, v47, v48, v49
    v_mfma_f32_16x16x32_bf16 v[52:55], v[92:95], a[164:167], v[52:55]
    buffer_load_dwordx4 v10, s[16:19], s31 offen offset:0 nt lds
    v_max3_f32 v1, v50, v51, v1
    v_max_f32 v1, v1, v2
    v_mfma_f32_16x16x32_bf16 v[52:55], v[96:99], a[168:171], v[52:55]
    buffer_load_dwordx4 v11, s[16:19], s31 offen offset:1024 nt lds
    v_cmp_gt_f32 vcc, v1, v34
    s_cbranch_vccnz SLOW_0_4
RET_0_4:
    v_mfma_f32_16x16x32_bf16 v[52:55], v[100:103], a[172:175], v[52:55]
    buffer_load_dwordx4 v12, s[16:19], s31 offen offset:2048 nt lds
    v_fma_f32 v44, v44, s36, v39
    v_fma_f32 v45, v45, s36, v39
    v_mfma_f32_16x16x32_bf16 v[56:59], v[104:107], a[160:163], 0
    buffer_load_dwordx4 v13, s[16:19], s31 offen offset:3072 nt lds
    v_fma_f32 v46, v46, s36, v39
    v_fma_f32 v47, v47, s36, v39
    v_mfma_f32_16x16x32_bf16 v[56:59], v[108:111], a[164:167], v[56:59]
    s_add_u32 m0, s30, 12288
    v_fma_f32 v48, v48, s36, v39
    v_fma_f32 v49, v49, s36, v39
    v_mfma_f32_16x16x32_bf16 v[56:59], v[112:115], a[168:171], v[56:59]
    buffer_load_dwordx4 v10, s[16:19], s32 offen offset:0 nt lds
    v_fma_f32 v50, v50, s36, v39
    v_fma_f32 v51, v51, s36, v39
    v_mfma_f32_16x16x32_bf16 v[56:59], v[116:119], a[172:175], v[56:59]
    buffer_load_dwordx4 v11, s[16:19], s32 offen offset:1024 nt lds
    v_exp_f32 v44, v44
    v_mfma_f32_16x16x32_bf16 a[96:99], v[120:123], v[64:67], a[96:99]
    buffer_load_dwordx4 v12, s[16:19], s32 offen offset:2048 nt lds
    v_exp_f32 v45, v45
    v_mfma_f32_16x16x32_bf16 a[100:103], v[124:127], v[64:67], a[100:103]
    buffer_load_dwordx4 v13, s[16:19], s32 offen offset:3072 nt lds
    v_exp_f32 v46, v46
    v_mfma_f32_16x16x32_bf16 a[104:107], v[128:131], v[64:67], a[104:107]
    s_add_u32 s32, s31, 8192
    s_and_b32 s31, s32, 0xffff
    s_add_u32 s32, s31, 4096
    v_exp_f32 v47, v47
    v_mfma_f32_16x16x32_bf16 a[108:111], v[132:135], v[64:67], a[108:111]
    v_exp_f32 v48, v48
    v_mfma_f32_16x16x32_bf16 a[112:115], v[136:139], v[64:67], a[112:115]
    v_exp_f32 v49, v49
    v_mfma_f32_16x16x32_bf16 a[116:119], v[140:143], v[64:67], a[116:119]
    v_exp_f32 v50, v50
    v_mfma_f32_16x16x32_bf16 a[120:123], v[144:147], v[64:67], a[120:123]
    v_exp_f32 v51, v51
    v_mfma_f32_16x16x32_bf16 a[124:127], v[148:151], v[64:67], a[124:127]
    v_cvt_pk_bf16_f32 v60, v44, v45
    v_cvt_pk_bf16_f32 v61, v46, v47
    v_mfma_f32_16x16x32_bf16 v[80:83], v[40:43], v[64:67], v[80:83]
    v_cvt_pk_bf16_f32 v62, v48, v49
    v_cvt_pk_bf16_f32 v63, v50, v51
    s_mov_b32 s37, 0
    s_waitcnt vmcnt(24)
    v_mfma_f32_16x16x32_bf16 v[44:47], v[88:91], a[176:179], 0
    v_max3_f32 v1, v52, v53, v54
    v_max3_f32 v2, v55, v56, v57
    v_mfma_f32_16x16x32_bf16 v[44:47], v[92:95], a[180:183], v[44:47]
    v_max3_f32 v1, v58, v59, v1
    v_max_f32 v1, v1, v2
    v_mfma_f32_16x16x32_bf16 v[44:47], v[96:99], a[184:187], v[44:47]
    v_cmp_gt_f32 vcc, v1, v30
    s_cbranch_vccnz SLOW_1_0
RET_1_0:
    v_mfma_f32_16x16x32_bf16 v[44:47], v[100:103], a[188:191], v[44:47]
    v_fma_f32 v52, v52, s36, v35
    v_fma_f32 v53, v53, s36, v35
    v_mfma_f32_16x16x32_bf16 v[48:51], v[104:107], a[176:179], 0
    v_fma_f32 v54, v54, s36, v35
    v_fma_f32 v55, v55, s36, v35
    v_mfma_f32_16x16x32_bf16 v[48:51], v[108:111], a[180:183], v[48:51]
    v_fma_f32 v56, v56, s36, v35
    v_fma_f32 v57, v57, s36, v35
    v_mfma_f32_16x16x32_bf16 v[48:51], v[112:115], a[184:187], v[48:51]
    v_fma_f32 v58, v58, s36, v35
    v_fma_f32 v59, v59, s36, v35
    v_mfma_f32_16x16x32_bf16 v[48:51], v[116:119], a[188:191], v[48:51]
    v_exp_f32 v52, v52
    v_mfma_f32_16x16x32_bf16 a[128:131], v[120:123], v[60:63], a[128:131]
    ds_read_b64_tr_b16 v[120:121], v20 offset:24576
    ds_read_b64_tr_b16 v[122:123], v20 offset:28672
    v_exp_f32 v53, v53
    v_mfma_f32_16x16x32_bf16 a[132:135], v[124:127], v[60:63], a[132:135]
    ds_read_b64_tr_b16 v[124:125], v21 offset:24576
    ds_read_b64_tr_b16 v[126:127], v21 offset:28672
    v_exp_f32 v54, v54
    v_mfma_f32_16x16x32_bf16 a[136:139], v[128:131], v[60:63], a[136:139]
    ds_read_b64_tr_b16 v[128:129], v20 offset:24832
    ds_read_b64_tr_b16 v[130:131], v20 offset:28928
    v_exp_f32 v55, v55
    v_mfma_f32_16x16x32_bf16 a[140:143], v[132:135], v[60:63], a[140:143]
    ds_read_b64_tr_b16 v[132:133], v21 offset:24832
    ds_read_b64_tr_b16 v[134:135], v21 offset:28928
    v_exp_f32 v56, v56
    v_mfma_f32_16x16x32_bf16 a[144:147], v[136:139], v[60:63], a[144:147]
    ds_read_b64_tr_b16 v[136:137], v20 offset:25088
    ds_read_b64_tr_b16 v[138:139], v20 offset:29184
    v_exp_f32 v57, v57
    v_mfma_f32_16x16x32_bf16 a[148:151], v[140:143], v[60:63], a[148:151]
    ds_read_b64_tr_b16 v[140:141], v21 offset:25088
    ds_read_b64_tr_b16 v[142:143], v21 offset:29184
    v_exp_f32 v58, v58
    v_mfma_f32_16x16x32_bf16 a[152:155], v[144:147], v[60:63], a[152:155]
    ds_read_b64_tr_b16 v[144:145], v20 offset:25344
    ds_read_b64_tr_b16 v[146:147], v20 offset:29440
    v_exp_f32 v59, v59
    v_mfma_f32_16x16x32_bf16 a[156:159], v[148:151], v[60:63], a[156:159]
    ds_read_b64_tr_b16 v[148:149], v21 offset:25344
    ds_read_b64_tr_b16 v[150:151], v21 offset:29440
    v_cvt_pk_bf16_f32 v64, v52, v53
    v_cvt_pk_bf16_f32 v65, v54, v55
    v_mfma_f32_16x16x32_bf16 v[84:87], v[40:43], v[60:63], v[84:87]
    v_cvt_pk_bf16_f32 v66, v56, v57
    v_cvt_pk_bf16_f32 v67, v58, v59
    s_waitcnt lgkmcnt(0)
    v_mfma_f32_16x16x32_bf16 v[52:55], v[88:91], a[192:195], 0
    s_add_u32 m0, s30, 24576
    v_max3_f32 v1, v44, v45, v46
    v_max3_f32 v2, v47, v48, v49
    v_mfma_f32_16x16x32_bf16 v[52:55], v[92:95], a[196:199], v[52:55]
    buffer_load_dwordx4 v14, s[20:23], s33 offen offset:0 nt lds
    v_max3_f32 v1, v50, v51, v1
    v_max_f32 v1, v1, v2
    v_mfma_f32_16x16x32_bf16 v[52:55], v[96:99], a[200:203], v[52:55]
    buffer_load_dwordx4 v15, s[20:23], s33 offen offset:1024 nt lds
    v_cmp_gt_f32 vcc, v1, v31
    s_cbranch_vccnz SLOW_1_1
RET_1_1:
    v_mfma_f32_16x16x32_bf16 v[52:55], v[100:103], a[204:207], v[52:55]
    buffer_load_dwordx4 v14, s[20:23], s33 offen offset:2048 nt lds
    v_fma_f32 v44, v44, s36, v36
    v_fma_f32 v45, v45, s36, v36
    v_mfma_f32_16x16x32_bf16 v[56:59], v[104:107], a[192:195], 0
    buffer_load_dwordx4 v15, s[20:23], s33 offen offset:3072 nt lds
    v_fma_f32 v46, v46, s36, v36
    v_fma_f32 v47, v47, s36, v36
    v_mfma_f32_16x16x32_bf16 v[56:59], v[108:111], a[196:199], v[56:59]
    s_add_u32 m0, s30, 28672
    v_fma_f32 v48, v48, s36, v36
    v_fma_f32 v49, v49, s36, v36
    v_mfma_f32_16x16x32_bf16 v[56:59], v[112:115], a[200:203], v[56:59]
    buffer_load_dwordx4 v14, s[20:23], s34 offen offset:0 nt lds
    v_fma_f32 v50, v50, s36, v36
    v_fma_f32 v51, v51, s36, v36
    v_mfma_f32_16x16x32_bf16 v[56:59], v[116:119], a[204:207], v[56:59]
    buffer_load_dwordx4 v15, s[20:23], s34 offen offset:1024 nt lds
    v_exp_f32 v44, v44
    v_mfma_f32_16x16x32_bf16 a[0:3], v[120:123], v[64:67], a[0:3]
    buffer_load_dwordx4 v14, s[20:23], s34 offen offset:2048 nt lds
    v_exp_f32 v45, v45
    v_mfma_f32_16x16x32_bf16 a[4:7], v[124:127], v[64:67], a[4:7]
    buffer_load_dwordx4 v15, s[20:23], s34 offen offset:3072 nt lds
    v_exp_f32 v46, v46
    v_mfma_f32_16x16x32_bf16 a[8:11], v[128:131], v[64:67], a[8:11]
    s_add_u32 s34, s33, 8192
    s_and_b32 s33, s34, 0xffff
    s_add_u32 s34, s33, 4096
    v_exp_f32 v47, v47
    v_mfma_f32_16x16x32_bf16 a[12:15], v[132:135], v[64:67], a[12:15]
    v_exp_f32 v48, v48
    v_mfma_f32_16x16x32_bf16 a[16:19], v[136:139], v[64:67], a[16:19]
    v_exp_f32 v49, v49
    v_mfma_f32_16x16x32_bf16 a[20:23], v[140:143], v[64:67], a[20:23]
    v_exp_f32 v50, v50
    v_mfma_f32_16x16x32_bf16 a[24:27], v[144:147], v[64:67], a[24:27]
    v_exp_f32 v51, v51
    v_mfma_f32_16x16x32_bf16 a[28:31], v[148:151], v[64:67], a[28:31]
    v_cvt_pk_bf16_f32 v60, v44, v45
    v_cvt_pk_bf16_f32 v61, v46, v47
    v_mfma_f32_16x16x32_bf16 v[68:71], v[40:43], v[64:67], v[68:71]
    v_cvt_pk_bf16_f32 v62, v48, v49
    v_cvt_pk_bf16_f32 v63, v50, v51
    v_mfma_f32_16x16x32_bf16 v[44:47], v[88:91], a[208:211], 0
    v_max3_f32 v1, v52, v53, v54
    v_max3_f32 v2, v55, v56, v57
    v_mfma_f32_16x16x32_bf16 v[44:47], v[92:95], a[212:215], v[44:47]
    v_max3_f32 v1, v58, v59, v1
    v_max_f32 v1, v1, v2
    v_mfma_f32_16x16x32_bf16 v[44:47], v[96:99], a[216:219], v[44:47]
    v_cmp_gt_f32 vcc, v1, v32
    s_cbranch_vccnz SLOW_1_2
RET_1_2:
    v_mfma_f32_16x16x32_bf16 v[44:47], v[100:103], a[220:223], v[44:47]
    v_fma_f32 v52, v52, s36, v37
    v_fma_f32 v53, v53, s36, v37
    v_mfma_f32_16x16x32_bf16 v[48:51], v[104:107], a[208:211], 0
    v_fma_f32 v54, v54, s36, v37
    v_fma_f32 v55, v55, s36, v37
    v_mfma_f32_16x16x32_bf16 v[48:51], v[108:111], a[212:215], v[48:51]
    v_fma_f32 v56, v56, s36, v37
    v_fma_f32 v57, v57, s36, v37
    v_mfma_f32_16x16x32_bf16 v[48:51], v[112:115], a[216:219], v[48:51]
    v_fma_f32 v58, v58, s36, v37
    v_fma_f32 v59, v59, s36, v37
    v_mfma_f32_16x16x32_bf16 v[48:51], v[116:119], a[220:223], v[48:51]
    v_exp_f32 v52, v52
    v_mfma_f32_16x16x32_bf16 a[32:35], v[120:123], v[60:63], a[32:35]
    v_exp_f32 v53, v53
    v_mfma_f32_16x16x32_bf16 a[36:39], v[124:127], v[60:63], a[36:39]
    v_exp_f32 v54, v54
    v_mfma_f32_16x16x32_bf16 a[40:43], v[128:131], v[60:63], a[40:43]
    v_exp_f32 v55, v55
    v_mfma_f32_16x16x32_bf16 a[44:47], v[132:135], v[60:63], a[44:47]
    v_exp_f32 v56, v56
    v_mfma_f32_16x16x32_bf16 a[48:51], v[136:139], v[60:63], a[48:51]
    v_exp_f32 v57, v57
    v_mfma_f32_16x16x32_bf16 a[52:55], v[140:143], v[60:63], a[52:55]
    v_exp_f32 v58, v58
    v_mfma_f32_16x16x32_bf16 a[56:59], v[144:147], v[60:63], a[56:59]
    v_exp_f32 v59, v59
    v_mfma_f32_16x16x32_bf16 a[60:63], v[148:151], v[60:63], a[60:63]
    v_cvt_pk_bf16_f32 v64, v52, v53
    v_cvt_pk_bf16_f32 v65, v54, v55
    v_mfma_f32_16x16x32_bf16 v[72:75], v[40:43], v[60:63], v[72:75]
    v_cvt_pk_bf16_f32 v66, v56, v57
    v_cvt_pk_bf16_f32 v67, v58, v59
    s_waitcnt vmcnt(24)
    v_mfma_f32_16x16x32_bf16 v[52:55], v[88:91], a[224:227], 0
    ds_read_b128 v[88:91], v16 offset:0
    v_max3_f32 v1, v44, v45, v46
    v_max3_f32 v2, v47, v48, v49
    v_mfma_f32_16x16x32_bf16 v[52:55], v[92:95], a[228:231], v[52:55]
    ds_read_b128 v[92:95], v17 offset:0
    v_max3_f32 v1, v50, v51, v1
    v_max_f32 v1, v1, v2
    v_mfma_f32_16x16x32_bf16 v[52:55], v[96:99], a[232:235], v[52:55]
    ds_read_b128 v[96:99], v18 offset:0
    v_cmp_gt_f32 vcc, v1, v33
    s_cbranch_vccnz SLOW_1_3
RET_1_3:
    v_mfma_f32_16x16x32_bf16 v[52:55], v[100:103], a[236:239], v[52:55]
    ds_read_b128 v[100:103], v19 offset:0
    v_fma_f32 v44, v44, s36, v38
    v_fma_f32 v45, v45, s36, v38
    v_mfma_f32_16x16x32_bf16 v[56:59], v[104:107], a[224:227], 0
    ds_read_b128 v[104:107], v16 offset:4096
    v_fma_f32 v46, v46, s36, v38
    v_fma_f32 v47, v47, s36, v38
    v_mfma_f32_16x16x32_bf16 v[56:59], v[108:111], a[228:231], v[56:59]
    ds_read_b128 v[108:111], v17 offset:4096
    v_fma_f32 v48, v48, s36, v38
    v_fma_f32 v49, v49, s36, v38
    v_mfma_f32_16x16x32_bf16 v[56:59], v[112:115], a[232:235], v[56:59]
    ds_read_b128 v[112:115], v18 offset:4096
    v_fma_f32 v50, v50, s36, v38
    v_fma_f32 v51, v51, s36, v38
    v_mfma_f32_16x16x32_bf16 v[56:59], v[116:119], a[236:239], v[56:59]
    ds_read_b128 v[116:119], v19 offset:4096
    v_exp_f32 v44, v44
    v_mfma_f32_16x16x32_bf16 a[64:67], v[120:123], v[64:67], a[64:67]
    v_exp_f32 v45, v45
    v_mfma_f32_16x16x32_bf16 a[68:71], v[124:127], v[64:67], a[68:71]
    v_exp_f32 v46, v46
    v_mfma_f32_16x16x32_bf16 a[72:75], v[128:131], v[64:67], a[72:75]
    v_exp_f32 v47, v47
    v_mfma_f32_16x16x32_bf16 a[76:79], v[132:135], v[64:67], a[76:79]
    v_exp_f32 v48, v48
    v_mfma_f32_16x16x32_bf16 a[80:83], v[136:139], v[64:67], a[80:83]
    v_exp_f32 v49, v49
    v_mfma_f32_16x16x32_bf16 a[84:87], v[140:143], v[64:67], a[84:87]
    v_exp_f32 v50, v50
    v_mfma_f32_16x16x32_bf16 a[88:91], v[144:147], v[64:67], a[88:91]
    v_exp_f32 v51, v51
    v_mfma_f32_16x16x32_bf16 a[92:95], v[148:151], v[64:67], a[92:95]
    v_cvt_pk_bf16_f32 v60, v44, v45
    v_cvt_pk_bf16_f32 v61, v46, v47
    v_mfma_f32_16x16x32_bf16 v[76:79], v[40:43], v[64:67], v[76:79]
    v_cvt_pk_bf16_f32 v62, v48, v49
    v_cvt_pk_bf16_f32 v63, v50, v51
    s_waitcnt lgkmcnt(0)
    v_mfma_f32_16x16x32_bf16 v[44:47], v[88:91], a[160:163], 0
    s_add_u32 m0, s30, 0
    v_max3_f32 v1, v52, v53, v54
    v_max3_f32 v2, v55, v56, v57
    v_mfma_f32_16x16x32_bf16 v[44:47], v[92:95], a[164:167], v[44:47]
    buffer_load_dwordx4 v10, s[16:19], s31 offen offset:0 nt lds
    v_max3_f32 v1, v58, v59, v1
    v_max_f32 v1, v1, v2
    v_mfma_f32_16x16x32_bf16 v[44:47], v[96:99], a[168:171], v[44:47]
    buffer_load_dwordx4 v11, s[16:19], s31 offen offset:1024 nt lds
    v_cmp_gt_f32 vcc, v1, v34
    s_cbranch_vccnz SLOW_1_4
RET_1_4:
    v_mfma_f32_16x16x32_bf16 v[44:47], v[100:103], a[172:175], v[44:47]
    buffer_load_dwordx4 v12, s[16:19], s31 offen offset:2048 nt lds
    v_fma_f32 v52, v52, s36, v39
    v_fma_f32 v53, v53, s36, v39
    v_mfma_f32_16x16x32_bf16 v[48:51], v[104:107], a[160:163], 0
    buffer_load_dwordx4 v13, s[16:19], s31 offen offset:3072 nt lds
    v_fma_f32 v54, v54, s36, v39
    v_fma_f32 v55, v55, s36, v39
    v_mfma_f32_16x16x32_bf16 v[48:51], v[108:111], a[164:167], v[48:51]
    s_add_u32 m0, s30, 4096
    v_fma_f32 v56, v56, s36, v39
    v_fma_f32 v57, v57, s36, v39
    v_mfma_f32_16x16x32_bf16 v[48:51], v[112:115], a[168:171], v[48:51]
    buffer_load_dwordx4 v10, s[16:19], s32 offen offset:0 nt lds
    v_fma_f32 v58, v58, s36, v39
    v_fma_f32 v59, v59, s36, v39
    v_mfma_f32_16x16x32_bf16 v[48:51], v[116:119], a[172:175], v[48:51]
    buffer_load_dwordx4 v11, s[16:19], s32 offen offset:1024 nt lds
    v_exp_f32 v52, v52
    v_mfma_f32_16x16x32_bf16 a[96:99], v[120:123], v[60:63], a[96:99]
    buffer_load_dwordx4 v12, s[16:19], s32 offen offset:2048 nt lds
    v_exp_f32 v53, v53
    v_mfma_f32_16x16x32_bf16 a[100:103], v[124:127], v[60:63], a[100:103]
    buffer_load_dwordx4 v13, s[16:19], s32 offen offset:3072 nt lds
    v_exp_f32 v54, v54
    v_mfma_f32_16x16x32_bf16 a[104:107], v[128:131], v[60:63], a[104:107]
    s_add_u32 s32, s31, 8192
    s_and_b32 s31, s32, 0xffff
    s_add_u32 s32, s31, 4096
    v_exp_f32 v55, v55
    v_mfma_f32_16x16x32_bf16 a[108:111], v[132:135], v[60:63], a[108:111]
    v_exp_f32 v56, v56
    v_mfma_f32_16x16x32_bf16 a[112:115], v[136:139], v[60:63], a[112:115]
    v_exp_f32 v57, v57
    v_mfma_f32_16x16x32_bf16 a[116:119], v[140:143], v[60:63], a[116:119]
    v_exp_f32 v58, v58
    v_mfma_f32_16x16x32_bf16 a[120:123], v[144:147], v[60:63], a[120:123]
    v_exp_f32 v59, v59
    v_mfma_f32_16x16x32_bf16 a[124:127], v[148:151], v[60:63], a[124:127]
    v_cvt_pk_bf16_f32 v64, v52, v53
    v_cvt_pk_bf16_f32 v65, v54, v55
    v_mfma_f32_16x16x32_bf16 v[80:83], v[40:43], v[60:63], v[80:83]
    v_cvt_pk_bf16_f32 v66, v56, v57
    v_cvt_pk_bf16_f32 v67, v58, v59
    s_add_u32 s35, s35, 1
    s_cmp_lt_u32 s35, 3
    s_cbranch_scc1 L_LOOP
    s_waitcnt vmcnt(16)
    v_mfma_f32_16x16x32_bf16 v[52:55], v[88:91], a[176:179], 0
    v_max3_f32 v1, v44, v45, v46
    v_max3_f32 v2, v47, v48, v49
    v_mfma_f32_16x16x32_bf16 v[52:55], v[92:95], a[180:183], v[52:55]
    v_max3_f32 v1, v50, v51, v1
    v_max_f32 v1, v1, v2
    v_mfma_f32_16x16x32_bf16 v[52:55], v[96:99], a[184:187], v[52:55]
    v_cmp_gt_f32 vcc, v1, v30
    s_cbranch_vccnz SLOW_6_0
RET_6_0:
    v_mfma_f32_16x16x32_bf16 v[52:55], v[100:103], a[188:191], v[52:55]
    v_fma_f32 v44, v44, s36, v35
    v_fma_f32 v45, v45, s36, v35
    v_mfma_f32_16x16x32_bf16 v[56:59], v[104:107], a[176:179], 0
    v_fma_f32 v46, v46, s36, v35
    v_fma_f32 v47, v47, s36, v35
    v_mfma_f32_16x16x32_bf16 v[56:59], v[108:111], a[180:183], v[56:59]
    v_fma_f32 v48, v48, s36, v35
    v_fma_f32 v49, v49, s36, v35
    v_mfma_f32_16x16x32_bf16 v[56:59], v[112:115], a[184:187], v[56:59]
    v_fma_f32 v50, v50, s36, v35
    v_fma_f32 v51, v51, s36, v35
    v_mfma_f32_16x16x32_bf16 v[56:59], v[116:119], a[188:191], v[56:59]
    v_exp_f32 v44, v44
    v_mfma_f32_16x16x32_bf16 a[128:131], v[120:123], v[64:67], a[128:131]
    ds_read_b64_tr_b16 v[120:121], v20 offset:16384
    ds_read_b64_tr_b16 v[122:123], v20 offset:20480
    v_exp_f32 v45, v45
    v_mfma_f32_16x16x32_bf16 a[132:135], v[124:127], v[64:67], a[132:135]
    ds_read_b64_tr_b16 v[124:125], v21 offset:16384
    ds_read_b64_tr_b16 v[126:127], v21 offset:20480
    v_exp_f32 v46, v46
    v_mfma_f32_16x16x32_bf16 a[136:139], v[128:131], v[64:67], a[136:139]
    ds_read_b64_tr_b16 v[128:129], v20 offset:16640
    ds_read_b64_tr_b16 v[130:131], v20 offset:20736
    v_exp_f32 v47, v47
    v_mfma_f32_16x16x32_bf16 a[140:143], v[132:135], v[64:67], a[140:143]
    ds_read_b64_tr_b16 v[132:133], v21 offset:16640
    ds_read_b64_tr_b16 v[134:135], v21 offset:20736
    v_exp_f32 v48, v48
    v_mfma_f32_16x16x32_bf16 a[144:147], v[136:139], v[64:67], a[144:147]
    ds_read_b64_tr_b16 v[136:137], v20 offset:16896
    ds_read_b64_tr_b16 v[138:139], v20 offset:20992
    v_exp_f32 v49, v49
    v_mfma_f32_16x16x32_bf16 a[148:151], v[140:143], v[64:67], a[148:151]
    ds_read_b64_tr_b16 v[140:141], v21 offset:16896
    ds_read_b64_tr_b16 v[142:143], v21 offset:20992
    v_exp_f32 v50, v50
    v_mfma_f32_16x16x32_bf16 a[152:155], v[144:147], v[64:67], a[152:155]
    ds_read_b64_tr_b16 v[144:145], v20 offset:17152
    ds_read_b64_tr_b16 v[146:147], v20 offset:21248
    v_exp_f32 v51, v51
    v_mfma_f32_16x16x32_bf16 a[156:159], v[148:151], v[64:67], a[156:159]
    ds_read_b64_tr_b16 v[148:149], v21 offset:17152
    ds_read_b64_tr_b16 v[150:151], v21 offset:21248
    v_cvt_pk_bf16_f32 v60, v44, v45
    v_cvt_pk_bf16_f32 v61, v46, v47
    v_mfma_f32_16x16x32_bf16 v[84:87], v[40:43], v[64:67], v[84:87]
    v_cvt_pk_bf16_f32 v62, v48, v49
    v_cvt_pk_bf16_f32 v63, v50, v51
    s_waitcnt lgkmcnt(0)
    v_mfma_f32_16x16x32_bf16 v[44:47], v[88:91], a[192:195], 0
    v_max3_f32 v1, v52, v53, v54
    v_max3_f32 v2, v55, v56, v57
    v_mfma_f32_16x16x32_bf16 v[44:47], v[92:95], a[196:199], v[44:47]
    v_max3_f32 v1, v58, v59, v1
    v_max_f32 v1, v1, v2
    v_mfma_f32_16x16x32_bf16 v[44:47], v[96:99], a[200:203], v[44:47]
    v_cmp_gt_f32 vcc, v1, v31
    s_cbranch_vccnz SLOW_6_1
RET_6_1:
    v_mfma_f32_16x16x32_bf16 v[44:47], v[100:103], a[204:207], v[44:47]
    v_fma_f32 v52, v52, s36, v36
    v_fma_f32 v53, v53, s36, v36
    v_mfma_f32_16x16x32_bf16 v[48:51], v[104:107], a[192:195], 0
    v_fma_f32 v54, v54, s36, v36
    v_fma_f32 v55, v55, s36, v36
    v_mfma_f32_16x16x32_bf16 v[48:51], v[108:111], a[196:199], v[48:51]
    v_fma_f32 v56, v56, s36, v36
    v_fma_f32 v57, v57, s36, v36
    v_mfma_f32_16x16x32_bf16 v[48:51], v[112:115], a[200:203], v[48:51]
    v_fma_f32 v58, v58, s36, v36
    v_fma_f32 v59, v59, s36, v36
    v_mfma_f32_16x16x32_bf16 v[48:51], v[116:119], a[204:207], v[48:51]
    v_exp_f32 v52, v52
    v_mfma_f32_16x16x32_bf16 a[0:3], v[120:123], v[60:63], a[0:3]
    v_exp_f32 v53, v53
    v_mfma_f32_16x16x32_bf16 a[4:7], v[124:127], v[60:63], a[4:7]
    v_exp_f32 v54, v54
    v_mfma_f32_16x16x32_bf16 a[8:11], v[128:131], v[60:63], a[8:11]
    v_exp_f32 v55, v55
    v_mfma_f32_16x16x32_bf16 a[12:15], v[132:135], v[60:63], a[12:15]
    v_exp_f32 v56, v56
    v_mfma_f32_16x16x32_bf16 a[16:19], v[136:139], v[60:63], a[16:19]
    v_exp_f32 v57, v57
    v_mfma_f32_16x16x32_bf16 a[20:23], v[140:143], v[60:63], a[20:23]
    v_exp_f32 v58, v58
    v_mfma_f32_16x16x32_bf16 a[24:27], v[144:147], v[60:63], a[24:27]
    v_exp_f32 v59, v59
    v_mfma_f32_16x16x32_bf16 a[28:31], v[148:151], v[60:63], a[28:31]
    v_cvt_pk_bf16_f32 v64, v52, v53
    v_cvt_pk_bf16_f32 v65, v54, v55
    v_mfma_f32_16x16x32_bf16 v[68:71], v[40:43], v[60:63], v[68:71]
    v_cvt_pk_bf16_f32 v66, v56, v57
    v_cvt_pk_bf16_f32 v67, v58, v59
    v_mfma_f32_16x16x32_bf16 v[52:55], v[88:91], a[208:211], 0
    v_max3_f32 v1, v44, v45, v46
    v_max3_f32 v2, v47, v48, v49
    v_mfma_f32_16x16x32_bf16 v[52:55], v[92:95], a[212:215], v[52:55]
    v_max3_f32 v1, v50, v51, v1
    v_max_f32 v1, v1, v2
    v_mfma_f32_16x16x32_bf16 v[52:55], v[96:99], a[216:219], v[52:55]
    v_cmp_gt_f32 vcc, v1, v32
    s_cbranch_vccnz SLOW_6_2
RET_6_2:
    v_mfma_f32_16x16x32_bf16 v[52:55], v[100:103], a[220:223], v[52:55]
    v_fma_f32 v44, v44, s36, v37
    v_fma_f32 v45, v45, s36, v37
    v_mfma_f32_16x16x32_bf16 v[56:59], v[104:107], a[208:211], 0
    v_fma_f32 v46, v46, s36, v37
    v_fma_f32 v47, v47, s36, v37
    v_mfma_f32_16x16x32_bf16 v[56:59], v[108:111], a[212:215], v[56:59]
    v_fma_f32 v48, v48, s36, v37
    v_fma_f32 v49, v49, s36, v37
    v_mfma_f32_16x16x32_bf16 v[56:59], v[112:115], a[216:219], v[56:59]
    v_fma_f32 v50, v50, s36, v37
    v_fma_f32 v51, v51, s36, v37
    v_mfma_f32_16x16x32_bf16 v[56:59], v[116:119], a[220:223], v[56:59]
    v_exp_f32 v44, v44
    v_mfma_f32_16x16x32_bf16 a[32:35], v[120:123], v[64:67], a[32:35]
    v_exp_f32 v45, v45
    v_mfma_f32_16x16x32_bf16 a[36:39], v[124:127], v[64:67], a[36:39]
    v_exp_f32 v46, v46
    v_mfma_f32_16x16x32_bf16 a[40:43], v[128:131], v[64:67], a[40:43]
    v_exp_f32 v47, v47
    v_mfma_f32_16x16x32_bf16 a[44:47], v[132:135], v[64:67], a[44:47]
    v_exp_f32 v48, v48
    v_mfma_f32_16x16x32_bf16 a[48:51], v[136:139], v[64:67], a[48:51]
    v_exp_f32 v49, v49
    v_mfma_f32_16x16x32_bf16 a[52:55], v[140:143], v[64:67], a[52:55]
    v_exp_f32 v50, v50
    v_mfma_f32_16x16x32_bf16 a[56:59], v[144:147], v[64:67], a[56:59]
    v_exp_f32 v51, v51
    v_mfma_f32_16x16x32_bf16 a[60:63], v[148:151], v[64:67], a[60:63]
    v_cvt_pk_bf16_f32 v60, v44, v45
    v_cvt_pk_bf16_f32 v61, v46, v47
    v_mfma_f32_16x16x32_bf16 v[72:75], v[40:43], v[64:67], v[72:75]
    v_cvt_pk_bf16_f32 v62, v48, v49
    v_cvt_pk_bf16_f32 v63, v50, v51
    s_waitcnt vmcnt(8)
    v_mfma_f32_16x16x32_bf16 v[44:47], v[88:91], a[224:227], 0
    ds_read_b128 v[88:91], v16 offset:8192
    v_max3_f32 v1, v52, v53, v54
    v_max3_f32 v2, v55, v56, v57
    v_mfma_f32_16x16x32_bf16 v[44:47], v[92:95], a[228:231], v[44:47]
    ds_read_b128 v[92:95], v17 offset:8192
    v_max3_f32 v1, v58, v59, v1
    v_max_f32 v1, v1, v2
    v_mfma_f32_16x16x32_bf16 v[44:47], v[96:99], a[232:235], v[44:47]
    ds_read_b128 v[96:99], v18 offset:8192
    v_cmp_gt_f32 vcc, v1, v33
    s_cbranch_vccnz SLOW_6_3
RET_6_3:
    v_mfma_f32_16x16x32_bf16 v[44:47], v[100:103], a[236:239], v[44:47]
    ds_read_b128 v[100:103], v19 offset:8192
    v_fma_f32 v52, v52, s36, v38
    v_fma_f32 v53, v53, s36, v38
    v_mfma_f32_16x16x32_bf16 v[48:51], v[104:107], a[224:227], 0
    ds_read_b128 v[104:107], v16 offset:12288
    v_fma_f32 v54, v54, s36, v38
    v_fma_f32 v55, v55, s36, v38
    v_mfma_f32_16x16x32_bf16 v[48:51], v[108:111], a[228:231], v[48:51]
    ds_read_b128 v[108:111], v17 offset:12288
    v_fma_f32 v56, v56, s36, v38
    v_fma_f32 v57, v57, s36, v38
    v_mfma_f32_16x16x32_bf16 v[48:51], v[112:115], a[232:235], v[48:51]
    ds_read_b128 v[112:115], v18 offset:12288
    v_fma_f32 v58, v58, s36, v38
    v_fma_f32 v59, v59, s36, v38
    v_mfma_f32_16x16x32_bf16 v[48:51], v[116:119], a[236:239], v[48:51]
    ds_read_b128 v[116:119], v19 offset:12288
    v_exp_f32 v52, v52
    v_mfma_f32_16x16x32_bf16 a[64:67], v[120:123], v[60:63], a[64:67]
    v_exp_f32 v53, v53
    v_mfma_f32_16x16x32_bf16 a[68:71], v[124:127], v[60:63], a[68:71]
    v_exp_f32 v54, v54
    v_mfma_f32_16x16x32_bf16 a[72:75], v[128:131], v[60:63], a[72:75]
    v_exp_f32 v55, v55
    v_mfma_f32_16x16x32_bf16 a[76:79], v[132:135], v[60:63], a[76:79]
    v_exp_f32 v56, v56
    v_mfma_f32_16x16x32_bf16 a[80:83], v[136:139], v[60:63], a[80:83]
    v_exp_f32 v57, v57
    v_mfma_f32_16x16x32_bf16 a[84:87], v[140:143], v[60:63], a[84:87]
    v_exp_f32 v58, v58
    v_mfma_f32_16x16x32_bf16 a[88:91], v[144:147], v[60:63], a[88:91]
    v_exp_f32 v59, v59
    v_mfma_f32_16x16x32_bf16 a[92:95], v[148:151], v[60:63], a[92:95]
    v_cvt_pk_bf16_f32 v64, v52, v53
    v_cvt_pk_bf16_f32 v65, v54, v55
    v_mfma_f32_16x16x32_bf16 v[76:79], v[40:43], v[60:63], v[76:79]
    v_cvt_pk_bf16_f32 v66, v56, v57
    v_cvt_pk_bf16_f32 v67, v58, v59
    s_waitcnt lgkmcnt(0)
    v_mfma_f32_16x16x32_bf16 v[52:55], v[88:91], a[160:163], 0
    v_max3_f32 v1, v44, v45, v46
    v_max3_f32 v2, v47, v48, v49
    v_mfma_f32_16x16x32_bf16 v[52:55], v[92:95], a[164:167], v[52:55]
    v_max3_f32 v1, v50, v51, v1
    v_max_f32 v1, v1, v2
    v_mfma_f32_16x16x32_bf16 v[52:55], v[96:99], a[168:171], v[52:55]
    v_cmp_gt_f32 vcc, v1, v34
    s_cbranch_vccnz SLOW_6_4
RET_6_4:
    v_mfma_f32_16x16x32_bf16 v[52:55], v[100:103], a[172:175], v[52:55]
    v_fma_f32 v44, v44, s36, v39
    v_fma_f32 v45, v45, s36, v39
    v_mfma_f32_16x16x32_bf16 v[56:59], v[104:107], a[160:163], 0
    v_fma_f32 v46, v46, s36, v39
    v_fma_f32 v47, v47, s36, v39
    v_mfma_f32_16x16x32_bf16 v[56:59], v[108:111], a[164:167], v[56:59]
    v_fma_f32 v48, v48, s36, v39
    v_fma_f32 v49, v49, s36, v39
    v_mfma_f32_16x16x32_bf16 v[56:59], v[112:115], a[168:171], v[56:59]
    v_fma_f32 v50, v50, s36, v39
    v_fma_f32 v51, v51, s36, v39
    v_mfma_f32_16x16x32_bf16 v[56:59], v[116:119], a[172:175], v[56:59]
    v_exp_f32 v44, v44
    v_mfma_f32_16x16x32_bf16 a[96:99], v[120:123], v[64:67], a[96:99]
    v_exp_f32 v45, v45
    v_mfma_f32_16x16x32_bf16 a[100:103], v[124:127], v[64:67], a[100:103]
    v_exp_f32 v46, v46
    v_mfma_f32_16x16x32_bf16 a[104:107], v[128:131], v[64:67], a[104:107]
    v_exp_f32 v47, v47
    v_mfma_f32_16x16x32_bf16 a[108:111], v[132:135], v[64:67], a[108:111]
    v_exp_f32 v48, v48
    v_mfma_f32_16x16x32_bf16 a[112:115], v[136:139], v[64:67], a[112:115]
    v_exp_f32 v49, v49
    v_mfma_f32_16x16x32_bf16 a[116:119], v[140:143], v[64:67], a[116:119]
    v_exp_f32 v50, v50
    v_mfma_f32_16x16x32_bf16 a[120:123], v[144:147], v[64:67], a[120:123]
    v_exp_f32 v51, v51
    v_mfma_f32_16x16x32_bf16 a[124:127], v[148:151], v[64:67], a[124:127]
    v_cvt_pk_bf16_f32 v60, v44, v45
    v_cvt_pk_bf16_f32 v61, v46, v47
    v_mfma_f32_16x16x32_bf16 v[80:83], v[40:43], v[64:67], v[80:83]
    v_cvt_pk_bf16_f32 v62, v48, v49
    v_cvt_pk_bf16_f32 v63, v50, v51
    s_waitcnt vmcnt(0)
    v_mfma_f32_16x16x32_bf16 v[44:47], v[88:91], a[176:179], 0
    v_max3_f32 v1, v52, v53, v54
    v_max3_f32 v2, v55, v56, v57
    v_mfma_f32_16x16x32_bf16 v[44:47], v[92:95], a[180:183], v[44:47]
    v_max3_f32 v1, v58, v59, v1
    v_max_f32 v1, v1, v2
    v_mfma_f32_16x16x32_bf16 v[44:47], v[96:99], a[184:187], v[44:47]
    v_cmp_gt_f32 vcc, v1, v30
    s_cbranch_vccnz SLOW_7_0
RET_7_0:
    v_mfma_f32_16x16x32_bf16 v[44:47], v[100:103], a[188:191], v[44:47]
    v_fma_f32 v52, v52, s36, v35
    v_fma_f32 v53, v53, s36, v35
    v_mfma_f32_16x16x32_bf16 v[48:51], v[104:107], a[176:179], 0
    v_fma_f32 v54, v54, s36, v35
    v_fma_f32 v55, v55, s36, v35
    v_mfma_f32_16x16x32_bf16 v[48:51], v[108:111], a[180:183], v[48:51]
    v_fma_f32 v56, v56, s36, v35
    v_fma_f32 v57, v57, s36, v35
    v_mfma_f32_16x16x32_bf16 v[48:51], v[112:115], a[184:187], v[48:51]
    v_fma_f32 v58, v58, s36, v35
    v_fma_f32 v59, v59, s36, v35
    v_mfma_f32_16x16x32_bf16 v[48:51], v[116:119], a[188:191], v[48:51]
    v_exp_f32 v52, v52
    v_mfma_f32_16x16x32_bf16 a[128:131], v[120:123], v[60:63], a[128:131]
    ds_read_b64_tr_b16 v[120:121], v20 offset:24576
    ds_read_b64_tr_b16 v[122:123], v20 offset:28672
    v_exp_f32 v53, v53
    v_mfma_f32_16x16x32_bf16 a[132:135], v[124:127], v[60:63], a[132:135]
    ds_read_b64_tr_b16 v[124:125], v21 offset:24576
    ds_read_b64_tr_b16 v[126:127], v21 offset:28672
    v_exp_f32 v54, v54
    v_mfma_f32_16x16x32_bf16 a[136:139], v[128:131], v[60:63], a[136:139]
    ds_read_b64_tr_b16 v[128:129], v20 offset:24832
    ds_read_b64_tr_b16 v[130:131], v20 offset:28928
    v_exp_f32 v55, v55
    v_mfma_f32_16x16x32_bf16 a[140:143], v[132:135], v[60:63], a[140:143]
    ds_read_b64_tr_b16 v[132:133], v21 offset:24832
    ds_read_b64_tr_b16 v[134:135], v21 offset:28928
    v_exp_f32 v56, v56
    v_mfma_f32_16x16x32_bf16 a[144:147], v[136:139], v[60:63], a[144:147]
    ds_read_b64_tr_b16 v[136:137], v20 offset:25088
    ds_read_b64_tr_b16 v[138:139], v20 offset:29184
    v_exp_f32 v57, v57
    v_mfma_f32_16x16x32_bf16 a[148:151], v[140:143], v[60:63], a[148:151]
    ds_read_b64_tr_b16 v[140:141], v21 offset:25088
    ds_read_b64_tr_b16 v[142:143], v21 offset:29184
    v_exp_f32 v58, v58
    v_mfma_f32_16x16x32_bf16 a[152:155], v[144:147], v[60:63], a[152:155]
    ds_read_b64_tr_b16 v[144:145], v20 offset:25344
    ds_read_b64_tr_b16 v[146:147], v20 offset:29440
    v_exp_f32 v59, v59
    v_mfma_f32_16x16x32_bf16 a[156:159], v[148:151], v[60:63], a[156:159]
    ds_read_b64_tr_b16 v[148:149], v21 offset:25344
    ds_read_b64_tr_b16 v[150:151], v21 offset:29440
    v_cvt_pk_bf16_f32 v64, v52, v53
    v_cvt_pk_bf16_f32 v65, v54, v55
    v_mfma_f32_16x16x32_bf16 v[84:87], v[40:43], v[60:63], v[84:87]
    v_cvt_pk_bf16_f32 v66, v56, v57
    v_cvt_pk_bf16_f32 v67, v58, v59
    s_waitcnt lgkmcnt(0)
    v_mfma_f32_16x16x32_bf16 v[52:55], v[88:91], a[192:195], 0
    v_max3_f32 v1, v44, v45, v46
    v_max3_f32 v2, v47, v48, v49
    v_mfma_f32_16x16x32_bf16 v[52:55], v[92:95], a[196:199], v[52:55]
    v_max3_f32 v1, v50, v51, v1
    v_max_f32 v1, v1, v2
    v_mfma_f32_16x16x32_bf16 v[52:55], v[96:99], a[200:203], v[52:55]
    v_cmp_gt_f32 vcc, v1, v31
    s_cbranch_vccnz SLOW_7_1
RET_7_1:
    v_mfma_f32_16x16x32_bf16 v[52:55], v[100:103], a[204:207], v[52:55]
    v_fma_f32 v44, v44, s36, v36
    v_fma_f32 v45, v45, s36, v36
    v_mfma_f32_16x16x32_bf16 v[56:59], v[104:107], a[192:195], 0
    v_fma_f32 v46, v46, s36, v36
    v_fma_f32 v47, v47, s36, v36
    v_mfma_f32_16x16x32_bf16 v[56:59], v[108:111], a[196:199], v[56:59]
    v_fma_f32 v48, v48, s36, v36
    v_fma_f32 v49, v49, s36, v36
    v_mfma_f32_16x16x32_bf16 v[56:59], v[112:115], a[200:203], v[56:59]
    v_fma_f32 v50, v50, s36, v36
    v_fma_f32 v51, v51, s36, v36
    v_mfma_f32_16x16x32_bf16 v[56:59], v[116:119], a[204:207], v[56:59]
    v_exp_f32 v44, v44
    v_mfma_f32_16x16x32_bf16 a[0:3], v[120:123], v[64:67], a[0:3]
    v_exp_f32 v45, v45
    v_mfma_f32_16x16x32_bf16 a[4:7], v[124:127], v[64:67], a[4:7]
    v_exp_f32 v46, v46
    v_mfma_f32_16x16x32_bf16 a[8:11], v[128:131], v[64:67], a[8:11]
    v_exp_f32 v47, v47
    v_mfma_f32_16x16x32_bf16 a[12:15], v[132:135], v[64:67], a[12:15]
    v_exp_f32 v48, v48
    v_mfma_f32_16x16x32_bf16 a[16:19], v[136:139], v[64:67], a[16:19]
    v_exp_f32 v49, v49
    v_mfma_f32_16x16x32_bf16 a[20:23], v[140:143], v[64:67], a[20:23]
    v_exp_f32 v50, v50
    v_mfma_f32_16x16x32_bf16 a[24:27], v[144:147], v[64:67], a[24:27]
    v_exp_f32 v51, v51
    v_mfma_f32_16x16x32_bf16 a[28:31], v[148:151], v[64:67], a[28:31]
    v_cvt_pk_bf16_f32 v60, v44, v45
    v_cvt_pk_bf16_f32 v61, v46, v47
    v_mfma_f32_16x16x32_bf16 v[68:71], v[40:43], v[64:67], v[68:71]
    v_cvt_pk_bf16_f32 v62, v48, v49
    v_cvt_pk_bf16_f32 v63, v50, v51
    v_mfma_f32_16x16x32_bf16 v[44:47], v[88:91], a[208:211], 0
    v_max3_f32 v1, v52, v53, v54
    v_max3_f32 v2, v55, v56, v57
    v_mfma_f32_16x16x32_bf16 v[44:47], v[92:95], a[212:215], v[44:47]
    v_max3_f32 v1, v58, v59, v1
    v_max_f32 v1, v1, v2
    v_mfma_f32_16x16x32_bf16 v[44:47], v[96:99], a[216:219], v[44:47]
    v_cmp_gt_f32 vcc, v1, v32
    s_cbranch_vccnz SLOW_7_2
RET_7_2:
    v_mfma_f32_16x16x32_bf16 v[44:47], v[100:103], a[220:223], v[44:47]
    v_fma_f32 v52, v52, s36, v37
    v_fma_f32 v53, v53, s36, v37
    v_mfma_f32_16x16x32_bf16 v[48:51], v[104:107], a[208:211], 0
    v_fma_f32 v54, v54, s36, v37
    v_fma_f32 v55, v55, s36, v37
    v_mfma_f32_16x16x32_bf16 v[48:51], v[108:111], a[212:215], v[48:51]
    v_fma_f32 v56, v56, s36, v37
    v_fma_f32 v57, v57, s36, v37
    v_mfma_f32_16x16x32_bf16 v[48:51], v[112:115], a[216:219], v[48:51]
    v_fma_f32 v58, v58, s36, v37
    v_fma_f32 v59, v59, s36, v37
    v_mfma_f32_16x16x32_bf16 v[48:51], v[116:119], a[220:223], v[48:51]
    v_exp_f32 v52, v52
    v_mfma_f32_16x16x32_bf16 a[32:35], v[120:123], v[60:63], a[32:35]
    v_exp_f32 v53, v53
    v_mfma_f32_16x16x32_bf16 a[36:39], v[124:127], v[60:63], a[36:39]
    v_exp_f32 v54, v54
    v_mfma_f32_16x16x32_bf16 a[40:43], v[128:131], v[60:63], a[40:43]
    v_exp_f32 v55, v55
    v_mfma_f32_16x16x32_bf16 a[44:47], v[132:135], v[60:63], a[44:47]
    v_exp_f32 v56, v56
    v_mfma_f32_16x16x32_bf16 a[48:51], v[136:139], v[60:63], a[48:51]
    v_exp_f32 v57, v57
    v_mfma_f32_16x16x32_bf16 a[52:55], v[140:143], v[60:63], a[52:55]
    v_exp_f32 v58, v58
    v_mfma_f32_16x16x32_bf16 a[56:59], v[144:147], v[60:63], a[56:59]
    v_exp_f32 v59, v59
    v_mfma_f32_16x16x32_bf16 a[60:63], v[148:151], v[60:63], a[60:63]
    v_cvt_pk_bf16_f32 v64, v52, v53
    v_cvt_pk_bf16_f32 v65, v54, v55
    v_mfma_f32_16x16x32_bf16 v[72:75], v[40:43], v[60:63], v[72:75]
    v_cvt_pk_bf16_f32 v66, v56, v57
    v_cvt_pk_bf16_f32 v67, v58, v59
    v_mfma_f32_16x16x32_bf16 v[52:55], v[88:91], a[224:227], 0
    v_max3_f32 v1, v44, v45, v46
    v_max3_f32 v2, v47, v48, v49
    v_mfma_f32_16x16x32_bf16 v[52:55], v[92:95], a[228:231], v[52:55]
    v_max3_f32 v1, v50, v51, v1
    v_max_f32 v1, v1, v2
    v_mfma_f32_16x16x32_bf16 v[52:55], v[96:99], a[232:235], v[52:55]
    v_cmp_gt_f32 vcc, v1, v33
    s_cbranch_vccnz SLOW_7_3
RET_7_3:
    v_mfma_f32_16x16x32_bf16 v[52:55], v[100:103], a[236:239], v[52:55]
    v_fma_f32 v44, v44, s36, v38
    v_fma_f32 v45, v45, s36, v38
    v_mfma_f32_16x16x32_bf16 v[56:59], v[104:107], a[224:227], 0
    v_fma_f32 v46, v46, s36, v38
    v_fma_f32 v47, v47, s36, v38
    v_mfma_f32_16x16x32_bf16 v[56:59], v[108:111], a[228:231], v[56:59]
    v_fma_f32 v48, v48, s36, v38
    v_fma_f32 v49, v49, s36, v38
    v_mfma_f32_16x16x32_bf16 v[56:59], v[112:115], a[232:235], v[56:59]
    v_fma_f32 v50, v50, s36, v38
    v_fma_f32 v51, v51, s36, v38
    v_mfma_f32_16x16x32_bf16 v[56:59], v[116:119], a[236:239], v[56:59]
    v_exp_f32 v44, v44
    v_mfma_f32_16x16x32_bf16 a[64:67], v[120:123], v[64:67], a[64:67]
    v_exp_f32 v45, v45
    v_mfma_f32_16x16x32_bf16 a[68:71], v[124:127], v[64:67], a[68:71]
    v_exp_f32 v46, v46
    v_mfma_f32_16x16x32_bf16 a[72:75], v[128:131], v[64:67], a[72:75]
    v_exp_f32 v47, v47
    v_mfma_f32_16x16x32_bf16 a[76:79], v[132:135], v[64:67], a[76:79]
    v_exp_f32 v48, v48
    v_mfma_f32_16x16x32_bf16 a[80:83], v[136:139], v[64:67], a[80:83]
    v_exp_f32 v49, v49
    v_mfma_f32_16x16x32_bf16 a[84:87], v[140:143], v[64:67], a[84:87]
    v_exp_f32 v50, v50
    v_mfma_f32_16x16x32_bf16 a[88:91], v[144:147], v[64:67], a[88:91]
    v_exp_f32 v51, v51
    v_mfma_f32_16x16x32_bf16 a[92:95], v[148:151], v[64:67], a[92:95]
    v_cvt_pk_bf16_f32 v60, v44, v45
    v_cvt_pk_bf16_f32 v61, v46, v47
    v_mfma_f32_16x16x32_bf16 v[76:79], v[40:43], v[64:67], v[76:79]
    v_cvt_pk_bf16_f32 v62, v48, v49
    v_cvt_pk_bf16_f32 v63, v50, v51
    s_nop 1
    v_mfma_f32_16x16x32_bf16 a[96:99], v[120:123], v[60:63], a[96:99]
    v_max3_f32 v1, v52, v53, v54
    v_max3_f32 v2, v55, v56, v57
    v_mfma_f32_16x16x32_bf16 a[100:103], v[124:127], v[60:63], a[100:103]
    v_max3_f32 v1, v58, v59, v1
    v_max_f32 v1, v1, v2
    v_mfma_f32_16x16x32_bf16 a[104:107], v[128:131], v[60:63], a[104:107]
    v_cmp_gt_f32 vcc, v1, v34
    s_cbranch_vccnz SLOW_7_4
RET_7_4:
    v_mfma_f32_16x16x32_bf16 a[108:111], v[132:135], v[60:63], a[108:111]
    v_fma_f32 v52, v52, s36, v39
    v_fma_f32 v53, v53, s36, v39
    v_mfma_f32_16x16x32_bf16 a[112:115], v[136:139], v[60:63], a[112:115]
    v_fma_f32 v54, v54, s36, v39
    v_fma_f32 v55, v55, s36, v39
    v_mfma_f32_16x16x32_bf16 a[116:119], v[140:143], v[60:63], a[116:119]
    v_fma_f32 v56, v56, s36, v39
    v_fma_f32 v57, v57, s36, v39
    v_mfma_f32_16x16x32_bf16 a[120:123], v[144:147], v[60:63], a[120:123]
    v_fma_f32 v58, v58, s36, v39
    v_fma_f32 v59, v59, s36, v39
    v_mfma_f32_16x16x32_bf16 a[124:127], v[148:151], v[60:63], a[124:127]
    v_exp_f32 v52, v52
    v_mfma_f32_16x16x32_bf16 v[80:83], v[40:43], v[60:63], v[80:83]
    v_exp_f32 v53, v53
    v_exp_f32 v54, v54
    v_exp_f32 v55, v55
    v_exp_f32 v56, v56
    v_exp_f32 v57, v57
    v_exp_f32 v58, v58
    v_exp_f32 v59, v59
    v_cvt_pk_bf16_f32 v64, v52, v53
    v_cvt_pk_bf16_f32 v65, v54, v55
    v_cvt_pk_bf16_f32 v66, v56, v57
    v_cvt_pk_bf16_f32 v67, v58, v59
    s_nop 1
    v_mfma_f32_16x16x32_bf16 a[128:131], v[120:123], v[64:67], a[128:131]
    v_mfma_f32_16x16x32_bf16 a[132:135], v[124:127], v[64:67], a[132:135]
    v_mfma_f32_16x16x32_bf16 a[136:139], v[128:131], v[64:67], a[136:139]
    v_mfma_f32_16x16x32_bf16 a[140:143], v[132:135], v[64:67], a[140:143]
    v_mfma_f32_16x16x32_bf16 a[144:147], v[136:139], v[64:67], a[144:147]
    v_mfma_f32_16x16x32_bf16 a[148:151], v[140:143], v[64:67], a[148:151]
    v_mfma_f32_16x16x32_bf16 a[152:155], v[144:147], v[64:67], a[152:155]
    v_mfma_f32_16x16x32_bf16 a[156:159], v[148:151], v[64:67], a[156:159]
    v_mfma_f32_16x16x32_bf16 v[84:87], v[40:43], v[64:67], v[84:87]
    s_waitcnt vmcnt(0)
    s_nop 7
    s_nop 7
    v_and_b32 v1, 15, v0
    s_mul_i32 s29, s28, 640
    s_add_u32 s29, s29, 131072
    v_lshl_add_u32 v2, v1, 3, s29
    v_lshlrev_b32 v1, 3, v1
    v_add_u32 v1, 131072, v1
    ds_write2_b32 v2, v25, v68 offset0:0 offset1:1
    ds_write2_b32 v2, v26, v72 offset0:32 offset1:33
    ds_write2_b32 v2, v27, v76 offset0:64 offset1:65
    ds_write2_b32 v2, v28, v80 offset0:96 offset1:97
    ds_write2_b32 v2, v29, v84 offset0:128 offset1:129
    s_cmp_eq_u32 s28, 1
    s_cbranch_scc1 L_EPI1
    s_cmp_eq_u32 s28, 2
    s_cbranch_scc1 L_EPI2
    s_cmp_eq_u32 s28, 3
    s_cbranch_scc1 L_EPI3
L_EPI0:
    v_add_u32 v152, 0, v23
    ds_write_b128 v152, a[8:11] offset:0
    ds_write_b128 v152, a[40:43] offset:1024
    ds_write_b128 v152, a[72:75] offset:2048
    ds_write_b128 v152, a[104:107] offset:3072
    ds_write_b128 v152, a[136:139] offset:4096
    ds_write_b128 v152, a[12:15] offset:5120
    ds_write_b128 v152, a[44:47] offset:6144
    ds_write_b128 v152, a[76:79] offset:7168
    ds_write_b128 v152, a[108:111] offset:8192
    ds_write_b128 v152, a[140:143] offset:9216
    ds_write_b128 v152, a[16:19] offset:10240
    ds_write_b128 v152, a[48:51] offset:11264
    ds_write_b128 v152, a[80:83] offset:12288
    ds_write_b128 v152, a[112:115] offset:13312
    ds_write_b128 v152, a[144:147] offset:14336
    ds_write_b128 v152, a[20:23] offset:15360
    ds_write_b128 v152, a[52:55] offset:16384
    ds_write_b128 v152, a[84:87] offset:17408
    ds_write_b128 v152, a[116:119] offset:18432
    ds_write_b128 v152, a[148:151] offset:19456
    ds_write_b128 v152, a[24:27] offset:20480
    ds_write_b128 v152, a[56:59] offset:21504
    ds_write_b128 v152, a[88:91] offset:22528
    ds_write_b128 v152, a[120:123] offset:23552
    ds_write_b128 v152, a[152:155] offset:24576
    ds_write_b128 v152, a[28:31] offset:25600
    ds_write_b128 v152, a[60:63] offset:26624
    ds_write_b128 v152, a[92:95] offset:27648
    ds_write_b128 v152, a[124:127] offset:28672
    ds_write_b128 v152, a[156:159] offset:29696
    s_waitcnt lgkmcnt(0)
    s_barrier
    v_add_u32 v240, 53248, v23
    v_add_u32 v241, 75776, v23
    v_add_u32 v242, 98304, v23
    ds_read_b64 v[164:165], v1 offset:0
    ds_read_b64 v[166:167], v1 offset:128
    ds_read_b64 v[168:169], v1 offset:256
    ds_read_b64 v[170:171], v1 offset:384
    ds_read_b64 v[172:173], v1 offset:512
    ds_read_b64 v[174:175], v1 offset:640
    ds_read_b64 v[176:177], v1 offset:768
    ds_read_b64 v[178:179], v1 offset:896
    ds_read_b64 v[180:181], v1 offset:1024
    ds_read_b64 v[182:183], v1 offset:1152
    ds_read_b64 v[184:185], v1 offset:1280
    ds_read_b64 v[186:187], v1 offset:1408
    ds_read_b64 v[188:189], v1 offset:1536
    ds_read_b64 v[190:191], v1 offset:1664
    ds_read_b64 v[192:193], v1 offset:1792
    ds_read_b64 v[194:195], v1 offset:1920
    ds_read_b64 v[196:197], v1 offset:2048
    ds_read_b64 v[198:199], v1 offset:2176
    ds_read_b64 v[200:201], v1 offset:2304
    ds_read_b64 v[202:203], v1 offset:2432
    ds_read_b128 v[44:47], v240 offset:0
    ds_read_b128 v[48:51], v241 offset:0
    ds_read_b128 v[52:55], v242 offset:0
    ds_read_b128 v[56:59], v240 offset:1024
    ds_read_b128 v[60:63], v241 offset:1024
    ds_read_b128 v[64:67], v242 offset:1024
    ds_read_b128 v[68:71], v240 offset:2048
    ds_read_b128 v[72:75], v241 offset:2048
    ds_read_b128 v[76:79], v242 offset:2048
    ds_read_b128 v[80:83], v240 offset:3072
    ds_read_b128 v[84:87], v241 offset:3072
    ds_read_b128 v[88:91], v242 offset:3072
    ds_read_b128 v[92:95], v240 offset:4096
    ds_read_b128 v[96:99], v241 offset:4096
    ds_read_b128 v[100:103], v242 offset:4096
    ds_read_b128 v[104:107], v240 offset:5120
    ds_read_b128 v[108:111], v241 offset:5120
    ds_read_b128 v[112:115], v242 offset:5120
    ds_read_b128 v[116:119], v240 offset:6144
    ds_read_b128 v[120:123], v241 offset:6144
    ds_read_b128 v[124:127], v242 offset:6144
    ds_read_b128 v[128:131], v240 offset:7168
    ds_read_b128 v[132:135], v241 offset:7168
    ds_read_b128 v[136:139], v242 offset:7168
    ds_read_b128 v[140:143], v240 offset:8192
    ds_read_b128 v[144:147], v241 offset:8192
    ds_read_b128 v[148:151], v242 offset:8192
    ds_read_b128 v[152:155], v240 offset:9216
    ds_read_b128 v[156:159], v241 offset:9216
    ds_read_b128 v[160:163], v242 offset:9216
    s_waitcnt lgkmcnt(15)
    s_waitcnt lgkmcnt(15)
    s_waitcnt lgkmcnt(0)
    v_max3_f32 v3, v164, v174, v184
    v_max_f32 v3, v3, v194
    v_sub_f32 v204, v164, v3
    v_sub_f32 v209, v174, v3
    v_sub_f32 v214, v184, v3
    v_sub_f32 v219, v194, v3
    v_mul_f32 v204, s36, v204
    v_mul_f32 v209, s36, v209
    v_mul_f32 v214, s36, v214
    v_mul_f32 v219, s36, v219
    v_exp_f32 v204, v204
    v_exp_f32 v209, v209
    v_exp_f32 v214, v214
    v_exp_f32 v219, v219
    s_nop 0
    v_mul_f32 v4, v204, v165
    v_fmac_f32 v4, v209, v175
    v_fmac_f32 v4, v214, v185
    v_fmac_f32 v4, v219, v195
    v_rcp_f32 v4, v4
    s_nop 0
    v_mul_f32 v204, v204, v4
    v_mul_f32 v209, v209, v4
    v_mul_f32 v214, v214, v4
    v_mul_f32 v219, v219, v4
    v_max3_f32 v3, v166, v176, v186
    v_max_f32 v3, v3, v196
    v_sub_f32 v205, v166, v3
    v_sub_f32 v210, v176, v3
    v_sub_f32 v215, v186, v3
    v_sub_f32 v220, v196, v3
    v_mul_f32 v205, s36, v205
    v_mul_f32 v210, s36, v210
    v_mul_f32 v215, s36, v215
    v_mul_f32 v220, s36, v220
    v_exp_f32 v205, v205
    v_exp_f32 v210, v210
    v_exp_f32 v215, v215
    v_exp_f32 v220, v220
    s_nop 0
    v_mul_f32 v4, v205, v167
    v_fmac_f32 v4, v210, v177
    v_fmac_f32 v4, v215, v187
    v_fmac_f32 v4, v220, v197
    v_rcp_f32 v4, v4
    s_nop 0
    v_mul_f32 v205, v205, v4
    v_mul_f32 v210, v210, v4
    v_mul_f32 v215, v215, v4
    v_mul_f32 v220, v220, v4
    v_max3_f32 v3, v168, v178, v188
    v_max_f32 v3, v3, v198
    v_sub_f32 v206, v168, v3
    v_sub_f32 v211, v178, v3
    v_sub_f32 v216, v188, v3
    v_sub_f32 v221, v198, v3
    v_mul_f32 v206, s36, v206
    v_mul_f32 v211, s36, v211
    v_mul_f32 v216, s36, v216
    v_mul_f32 v221, s36, v221
    v_exp_f32 v206, v206
    v_exp_f32 v211, v211
    v_exp_f32 v216, v216
    v_exp_f32 v221, v221
    s_nop 0
    v_mul_f32 v4, v206, v169
    v_fmac_f32 v4, v211, v179
    v_fmac_f32 v4, v216, v189
    v_fmac_f32 v4, v221, v199
    v_rcp_f32 v4, v4
    s_nop 0
    v_mul_f32 v206, v206, v4
    v_mul_f32 v211, v211, v4
    v_mul_f32 v216, v216, v4
    v_mul_f32 v221, v221, v4
    v_max3_f32 v3, v170, v180, v190
    v_max_f32 v3, v3, v200
    v_sub_f32 v207, v170, v3
    v_sub_f32 v212, v180, v3
    v_sub_f32 v217, v190, v3
    v_sub_f32 v222, v200, v3
    v_mul_f32 v207, s36, v207
    v_mul_f32 v212, s36, v212
    v_mul_f32 v217, s36, v217
    v_mul_f32 v222, s36, v222
    v_exp_f32 v207, v207
    v_exp_f32 v212, v212
    v_exp_f32 v217, v217
    v_exp_f32 v222, v222
    s_nop 0
    v_mul_f32 v4, v207, v171
    v_fmac_f32 v4, v212, v181
    v_fmac_f32 v4, v217, v191
    v_fmac_f32 v4, v222, v201
    v_rcp_f32 v4, v4
    s_nop 0
    v_mul_f32 v207, v207, v4
    v_mul_f32 v212, v212, v4
    v_mul_f32 v217, v217, v4
    v_mul_f32 v222, v222, v4
    v_max3_f32 v3, v172, v182, v192
    v_max_f32 v3, v3, v202
    v_sub_f32 v208, v172, v3
    v_sub_f32 v213, v182, v3
    v_sub_f32 v218, v192, v3
    v_sub_f32 v223, v202, v3
    v_mul_f32 v208, s36, v208
    v_mul_f32 v213, s36, v213
    v_mul_f32 v218, s36, v218
    v_mul_f32 v223, s36, v223
    v_exp_f32 v208, v208
    v_exp_f32 v213, v213
    v_exp_f32 v218, v218
    v_exp_f32 v223, v223
    s_nop 0
    v_mul_f32 v4, v208, v173
    v_fmac_f32 v4, v213, v183
    v_fmac_f32 v4, v218, v193
    v_fmac_f32 v4, v223, v203
    v_rcp_f32 v4, v4
    s_nop 0
    v_mul_f32 v208, v208, v4
    v_mul_f32 v213, v213, v4
    v_mul_f32 v218, v218, v4
    v_mul_f32 v223, v223, v4
    v_accvgpr_read_b32 v224, a0
    v_accvgpr_read_b32 v225, a1
    v_accvgpr_read_b32 v226, a2
    v_accvgpr_read_b32 v227, a3
    s_nop 0
    v_mul_f32 v224, v224, v204
    v_mul_f32 v225, v225, v204
    v_mul_f32 v226, v226, v204
    v_mul_f32 v227, v227, v204
    v_fmac_f32 v224, v44, v209
    v_fmac_f32 v225, v45, v209
    v_fmac_f32 v226, v46, v209
    v_fmac_f32 v227, v47, v209
    v_fmac_f32 v224, v48, v214
    v_fmac_f32 v225, v49, v214
    v_fmac_f32 v226, v50, v214
    v_fmac_f32 v227, v51, v214
    v_fmac_f32 v224, v52, v219
    v_fmac_f32 v225, v53, v219
    v_fmac_f32 v226, v54, v219
    v_fmac_f32 v227, v55, v219
    v_cvt_pk_bf16_f32 v228, v224, v225
    v_cvt_pk_bf16_f32 v229, v226, v227
    buffer_store_dwordx2 v[228:229], v24, s[24:27], 0 offen offset:0
    s_nop 1
    v_accvgpr_read_b32 v224, a32
    v_accvgpr_read_b32 v225, a33
    v_accvgpr_read_b32 v226, a34
    v_accvgpr_read_b32 v227, a35
    s_nop 0
    v_mul_f32 v224, v224, v205
    v_mul_f32 v225, v225, v205
    v_mul_f32 v226, v226, v205
    v_mul_f32 v227, v227, v205
    v_fmac_f32 v224, v56, v210
    v_fmac_f32 v225, v57, v210
    v_fmac_f32 v226, v58, v210
    v_fmac_f32 v227, v59, v210
    v_fmac_f32 v224, v60, v215
    v_fmac_f32 v225, v61, v215
    v_fmac_f32 v226, v62, v215
    v_fmac_f32 v227, v63, v215
    v_fmac_f32 v224, v64, v220
    v_fmac_f32 v225, v65, v220
    v_fmac_f32 v226, v66, v220
    v_fmac_f32 v227, v67, v220
    v_cvt_pk_bf16_f32 v232, v224, v225
    v_cvt_pk_bf16_f32 v233, v226, v227
    s_mov_b32 s29, 4096
    buffer_store_dwordx2 v[232:233], v24, s[24:27], s29 offen offset:0
    s_nop 1
    v_accvgpr_read_b32 v224, a64
    v_accvgpr_read_b32 v225, a65
    v_accvgpr_read_b32 v226, a66
    v_accvgpr_read_b32 v227, a67
    s_nop 0
    v_mul_f32 v224, v224, v206
    v_mul_f32 v225, v225, v206
    v_mul_f32 v226, v226, v206
    v_mul_f32 v227, v227, v206
    v_fmac_f32 v224, v68, v211
    v_fmac_f32 v225, v69, v211
    v_fmac_f32 v226, v70, v211
    v_fmac_f32 v227, v71, v211
    v_fmac_f32 v224, v72, v216
    v_fmac_f32 v225, v73, v216
    v_fmac_f32 v226, v74, v216
    v_fmac_f32 v227, v75, v216
    v_fmac_f32 v224, v76, v221
    v_fmac_f32 v225, v77, v221
    v_fmac_f32 v226, v78, v221
    v_fmac_f32 v227, v79, v221
    v_cvt_pk_bf16_f32 v228, v224, v225
    v_cvt_pk_bf16_f32 v229, v226, v227
    s_mov_b32 s29, 8192
    buffer_store_dwordx2 v[228:229], v24, s[24:27], s29 offen offset:0
    s_nop 1
    v_accvgpr_read_b32 v224, a96
    v_accvgpr_read_b32 v225, a97
    v_accvgpr_read_b32 v226, a98
    v_accvgpr_read_b32 v227, a99
    s_nop 0
    v_mul_f32 v224, v224, v207
    v_mul_f32 v225, v225, v207
    v_mul_f32 v226, v226, v207
    v_mul_f32 v227, v227, v207
    v_fmac_f32 v224, v80, v212
    v_fmac_f32 v225, v81, v212
    v_fmac_f32 v226, v82, v212
    v_fmac_f32 v227, v83, v212
    v_fmac_f32 v224, v84, v217
    v_fmac_f32 v225, v85, v217
    v_fmac_f32 v226, v86, v217
    v_fmac_f32 v227, v87, v217
    v_fmac_f32 v224, v88, v222
    v_fmac_f32 v225, v89, v222
    v_fmac_f32 v226, v90, v222
    v_fmac_f32 v227, v91, v222
    v_cvt_pk_bf16_f32 v232, v224, v225
    v_cvt_pk_bf16_f32 v233, v226, v227
    s_mov_b32 s29, 12288
    buffer_store_dwordx2 v[232:233], v24, s[24:27], s29 offen offset:0
    s_nop 1
    v_accvgpr_read_b32 v224, a128
    v_accvgpr_read_b32 v225, a129
    v_accvgpr_read_b32 v226, a130
    v_accvgpr_read_b32 v227, a131
    s_nop 0
    v_mul_f32 v224, v224, v208
    v_mul_f32 v225, v225, v208
    v_mul_f32 v226, v226, v208
    v_mul_f32 v227, v227, v208
    v_fmac_f32 v224, v92, v213
    v_fmac_f32 v225, v93, v213
    v_fmac_f32 v226, v94, v213
    v_fmac_f32 v227, v95, v213
    v_fmac_f32 v224, v96, v218
    v_fmac_f32 v225, v97, v218
    v_fmac_f32 v226, v98, v218
    v_fmac_f32 v227, v99, v218
    v_fmac_f32 v224, v100, v223
    v_fmac_f32 v225, v101, v223
    v_fmac_f32 v226, v102, v223
    v_fmac_f32 v227, v103, v223
    v_cvt_pk_bf16_f32 v228, v224, v225
    v_cvt_pk_bf16_f32 v229, v226, v227
    s_mov_b32 s29, 16384
    buffer_store_dwordx2 v[228:229], v24, s[24:27], s29 offen offset:0
    s_nop 1
    v_accvgpr_read_b32 v224, a4
    v_accvgpr_read_b32 v225, a5
    v_accvgpr_read_b32 v226, a6
    v_accvgpr_read_b32 v227, a7
    s_nop 0
    v_mul_f32 v224, v224, v204
    v_mul_f32 v225, v225, v204
    v_mul_f32 v226, v226, v204
    v_mul_f32 v227, v227, v204
    v_fmac_f32 v224, v104, v209
    v_fmac_f32 v225, v105, v209
    v_fmac_f32 v226, v106, v209
    v_fmac_f32 v227, v107, v209
    v_fmac_f32 v224, v108, v214
    v_fmac_f32 v225, v109, v214
    v_fmac_f32 v226, v110, v214
    v_fmac_f32 v227, v111, v214
    v_fmac_f32 v224, v112, v219
    v_fmac_f32 v225, v113, v219
    v_fmac_f32 v226, v114, v219
    v_fmac_f32 v227, v115, v219
    v_cvt_pk_bf16_f32 v232, v224, v225
    v_cvt_pk_bf16_f32 v233, v226, v227
    buffer_store_dwordx2 v[232:233], v24, s[24:27], 0 offen offset:32
    s_nop 1
    v_accvgpr_read_b32 v224, a36
    v_accvgpr_read_b32 v225, a37
    v_accvgpr_read_b32 v226, a38
    v_accvgpr_read_b32 v227, a39
    s_nop 0
    v_mul_f32 v224, v224, v205
    v_mul_f32 v225, v225, v205
    v_mul_f32 v226, v226, v205
    v_mul_f32 v227, v227, v205
    v_fmac_f32 v224, v116, v210
    v_fmac_f32 v225, v117, v210
    v_fmac_f32 v226, v118, v210
    v_fmac_f32 v227, v119, v210
    v_fmac_f32 v224, v120, v215
    v_fmac_f32 v225, v121, v215
    v_fmac_f32 v226, v122, v215
    v_fmac_f32 v227, v123, v215
    v_fmac_f32 v224, v124, v220
    v_fmac_f32 v225, v125, v220
    v_fmac_f32 v226, v126, v220
    v_fmac_f32 v227, v127, v220
    v_cvt_pk_bf16_f32 v228, v224, v225
    v_cvt_pk_bf16_f32 v229, v226, v227
    s_mov_b32 s29, 4096
    buffer_store_dwordx2 v[228:229], v24, s[24:27], s29 offen offset:32
    s_nop 1
    v_accvgpr_read_b32 v224, a68
    v_accvgpr_read_b32 v225, a69
    v_accvgpr_read_b32 v226, a70
    v_accvgpr_read_b32 v227, a71
    s_nop 0
    v_mul_f32 v224, v224, v206
    v_mul_f32 v225, v225, v206
    v_mul_f32 v226, v226, v206
    v_mul_f32 v227, v227, v206
    v_fmac_f32 v224, v128, v211
    v_fmac_f32 v225, v129, v211
    v_fmac_f32 v226, v130, v211
    v_fmac_f32 v227, v131, v211
    v_fmac_f32 v224, v132, v216
    v_fmac_f32 v225, v133, v216
    v_fmac_f32 v226, v134, v216
    v_fmac_f32 v227, v135, v216
    v_fmac_f32 v224, v136, v221
    v_fmac_f32 v225, v137, v221
    v_fmac_f32 v226, v138, v221
    v_fmac_f32 v227, v139, v221
    v_cvt_pk_bf16_f32 v232, v224, v225
    v_cvt_pk_bf16_f32 v233, v226, v227
    s_mov_b32 s29, 8192
    buffer_store_dwordx2 v[232:233], v24, s[24:27], s29 offen offset:32
    s_nop 1
    v_accvgpr_read_b32 v224, a100
    v_accvgpr_read_b32 v225, a101
    v_accvgpr_read_b32 v226, a102
    v_accvgpr_read_b32 v227, a103
    s_nop 0
    v_mul_f32 v224, v224, v207
    v_mul_f32 v225, v225, v207
    v_mul_f32 v226, v226, v207
    v_mul_f32 v227, v227, v207
    v_fmac_f32 v224, v140, v212
    v_fmac_f32 v225, v141, v212
    v_fmac_f32 v226, v142, v212
    v_fmac_f32 v227, v143, v212
    v_fmac_f32 v224, v144, v217
    v_fmac_f32 v225, v145, v217
    v_fmac_f32 v226, v146, v217
    v_fmac_f32 v227, v147, v217
    v_fmac_f32 v224, v148, v222
    v_fmac_f32 v225, v149, v222
    v_fmac_f32 v226, v150, v222
    v_fmac_f32 v227, v151, v222
    v_cvt_pk_bf16_f32 v228, v224, v225
    v_cvt_pk_bf16_f32 v229, v226, v227
    s_mov_b32 s29, 12288
    buffer_store_dwordx2 v[228:229], v24, s[24:27], s29 offen offset:32
    s_nop 1
    v_accvgpr_read_b32 v224, a132
    v_accvgpr_read_b32 v225, a133
    v_accvgpr_read_b32 v226, a134
    v_accvgpr_read_b32 v227, a135
    s_nop 0
    v_mul_f32 v224, v224, v208
    v_mul_f32 v225, v225, v208
    v_mul_f32 v226, v226, v208
    v_mul_f32 v227, v227, v208
    v_fmac_f32 v224, v152, v213
    v_fmac_f32 v225, v153, v213
    v_fmac_f32 v226, v154, v213
    v_fmac_f32 v227, v155, v213
    v_fmac_f32 v224, v156, v218
    v_fmac_f32 v225, v157, v218
    v_fmac_f32 v226, v158, v218
    v_fmac_f32 v227, v159, v218
    v_fmac_f32 v224, v160, v223
    v_fmac_f32 v225, v161, v223
    v_fmac_f32 v226, v162, v223
    v_fmac_f32 v227, v163, v223
    v_cvt_pk_bf16_f32 v232, v224, v225
    v_cvt_pk_bf16_f32 v233, v226, v227
    s_mov_b32 s29, 16384
    buffer_store_dwordx2 v[232:233], v24, s[24:27], s29 offen offset:32
    s_nop 1
    s_waitcnt vmcnt(0)
    s_branch L_END
L_EPI1:
    v_add_u32 v152, 32768, v23
    ds_write_b128 v152, a[16:19] offset:0
    ds_write_b128 v152, a[48:51] offset:1024
    ds_write_b128 v152, a[80:83] offset:2048
    ds_write_b128 v152, a[112:115] offset:3072
    ds_write_b128 v152, a[144:147] offset:4096
    ds_write_b128 v152, a[20:23] offset:5120
    ds_write_b128 v152, a[52:55] offset:6144
    ds_write_b128 v152, a[84:87] offset:7168
    ds_write_b128 v152, a[116:119] offset:8192
    ds_write_b128 v152, a[148:151] offset:9216
    ds_write_b128 v152, a[24:27] offset:10240
    ds_write_b128 v152, a[56:59] offset:11264
    ds_write_b128 v152, a[88:91] offset:12288
    ds_write_b128 v152, a[120:123] offset:13312
    ds_write_b128 v152, a[152:155] offset:14336
    ds_write_b128 v152, a[28:31] offset:15360
    ds_write_b128 v152, a[60:63] offset:16384
    ds_write_b128 v152, a[92:95] offset:17408
    ds_write_b128 v152, a[124:127] offset:18432
    ds_write_b128 v152, a[156:159] offset:19456
    ds_write_b128 v152, a[0:3] offset:20480
    ds_write_b128 v152, a[32:35] offset:21504
    ds_write_b128 v152, a[64:67] offset:22528
    ds_write_b128 v152, a[96:99] offset:23552
    ds_write_b128 v152, a[128:131] offset:24576
    ds_write_b128 v152, a[4:7] offset:25600
    ds_write_b128 v152, a[36:39] offset:26624
    ds_write_b128 v152, a[68:71] offset:27648
    ds_write_b128 v152, a[100:103] offset:28672
    ds_write_b128 v152, a[132:135] offset:29696
    s_waitcnt lgkmcnt(0)
    s_barrier
    v_add_u32 v240, 0, v23
    v_add_u32 v241, 86016, v23
    v_add_u32 v242, 108544, v23
    ds_read_b64 v[164:165], v1 offset:0
    ds_read_b64 v[166:167], v1 offset:128
    ds_read_b64 v[168:169], v1 offset:256
    ds_read_b64 v[170:171], v1 offset:384
    ds_read_b64 v[172:173], v1 offset:512
    ds_read_b64 v[174:175], v1 offset:640
    ds_read_b64 v[176:177], v1 offset:768
    ds_read_b64 v[178:179], v1 offset:896
    ds_read_b64 v[180:181], v1 offset:1024
    ds_read_b64 v[182:183], v1 offset:1152
    ds_read_b64 v[184:185], v1 offset:1280
    ds_read_b64 v[186:187], v1 offset:1408
    ds_read_b64 v[188:189], v1 offset:1536
    ds_read_b64 v[190:191], v1 offset:1664
    ds_read_b64 v[192:193], v1 offset:1792
    ds_read_b64 v[194:195], v1 offset:1920
    ds_read_b64 v[196:197], v1 offset:2048
    ds_read_b64 v[198:199], v1 offset:2176
    ds_read_b64 v[200:201], v1 offset:2304
    ds_read_b64 v[202:203], v1 offset:2432
    ds_read_b128 v[44:47], v240 offset:0
    ds_read_b128 v[48:51], v241 offset:0
    ds_read_b128 v[52:55], v242 offset:0
    ds_read_b128 v[56:59], v240 offset:1024
    ds_read_b128 v[60:63], v241 offset:1024
    ds_read_b128 v[64:67], v242 offset:1024
    ds_read_b128 v[68:71], v240 offset:2048
    ds_read_b128 v[72:75], v241 offset:2048
    ds_read_b128 v[76:79], v242 offset:2048
    ds_read_b128 v[80:83], v240 offset:3072
    ds_read_b128 v[84:87], v241 offset:3072
    ds_read_b128 v[88:91], v242 offset:3072
    ds_read_b128 v[92:95], v240 offset:4096
    ds_read_b128 v[96:99], v241 offset:4096
    ds_read_b128 v[100:103], v242 offset:4096
    ds_read_b128 v[104:107], v240 offset:5120
    ds_read_b128 v[108:111], v241 offset:5120
    ds_read_b128 v[112:115], v242 offset:5120
    ds_read_b128 v[116:119], v240 offset:6144
    ds_read_b128 v[120:123], v241 offset:6144
    ds_read_b128 v[124:127], v242 offset:6144
    ds_read_b128 v[128:131], v240 offset:7168
    ds_read_b128 v[132:135], v241 offset:7168
    ds_read_b128 v[136:139], v242 offset:7168
    ds_read_b128 v[140:143], v240 offset:8192
    ds_read_b128 v[144:147], v241 offset:8192
    ds_read_b128 v[148:151], v242 offset:8192
    ds_read_b128 v[152:155], v240 offset:9216
    ds_read_b128 v[156:159], v241 offset:9216
    ds_read_b128 v[160:163], v242 offset:9216
    s_waitcnt lgkmcnt(15)
    s_waitcnt lgkmcnt(15)
    s_waitcnt lgkmcnt(0)
    v_max3_f32 v3, v164, v174, v184
    v_max_f32 v3, v3, v194
    v_sub_f32 v204, v164, v3
    v_sub_f32 v209, v174, v3
    v_sub_f32 v214, v184, v3
    v_sub_f32 v219, v194, v3
    v_mul_f32 v204, s36, v204
    v_mul_f32 v209, s36, v209
    v_mul_f32 v214, s36, v214
    v_mul_f32 v219, s36, v219
    v_exp_f32 v204, v204
    v_exp_f32 v209, v209
    v_exp_f32 v214, v214
    v_exp_f32 v219, v219
    s_nop 0
    v_mul_f32 v4, v204, v165
    v_fmac_f32 v4, v209, v175
    v_fmac_f32 v4, v214, v185
    v_fmac_f32 v4, v219, v195
    v_rcp_f32 v4, v4
    s_nop 0
    v_mul_f32 v204, v204, v4
    v_mul_f32 v209, v209, v4
    v_mul_f32 v214, v214, v4
    v_mul_f32 v219, v219, v4
    v_max3_f32 v3, v166, v176, v186
    v_max_f32 v3, v3, v196
    v_sub_f32 v205, v166, v3
    v_sub_f32 v210, v176, v3
    v_sub_f32 v215, v186, v3
    v_sub_f32 v220, v196, v3
    v_mul_f32 v205, s36, v205
    v_mul_f32 v210, s36, v210
    v_mul_f32 v215, s36, v215
    v_mul_f32 v220, s36, v220
    v_exp_f32 v205, v205
    v_exp_f32 v210, v210
    v_exp_f32 v215, v215
    v_exp_f32 v220, v220
    s_nop 0
    v_mul_f32 v4, v205, v167
    v_fmac_f32 v4, v210, v177
    v_fmac_f32 v4, v215, v187
    v_fmac_f32 v4, v220, v197
    v_rcp_f32 v4, v4
    s_nop 0
    v_mul_f32 v205, v205, v4
    v_mul_f32 v210, v210, v4
    v_mul_f32 v215, v215, v4
    v_mul_f32 v220, v220, v4
    v_max3_f32 v3, v168, v178, v188
    v_max_f32 v3, v3, v198
    v_sub_f32 v206, v168, v3
    v_sub_f32 v211, v178, v3
    v_sub_f32 v216, v188, v3
    v_sub_f32 v221, v198, v3
    v_mul_f32 v206, s36, v206
    v_mul_f32 v211, s36, v211
    v_mul_f32 v216, s36, v216
    v_mul_f32 v221, s36, v221
    v_exp_f32 v206, v206
    v_exp_f32 v211, v211
    v_exp_f32 v216, v216
    v_exp_f32 v221, v221
    s_nop 0
    v_mul_f32 v4, v206, v169
    v_fmac_f32 v4, v211, v179
    v_fmac_f32 v4, v216, v189
    v_fmac_f32 v4, v221, v199
    v_rcp_f32 v4, v4
    s_nop 0
    v_mul_f32 v206, v206, v4
    v_mul_f32 v211, v211, v4
    v_mul_f32 v216, v216, v4
    v_mul_f32 v221, v221, v4
    v_max3_f32 v3, v170, v180, v190
    v_max_f32 v3, v3, v200
    v_sub_f32 v207, v170, v3
    v_sub_f32 v212, v180, v3
    v_sub_f32 v217, v190, v3
    v_sub_f32 v222, v200, v3
    v_mul_f32 v207, s36, v207
    v_mul_f32 v212, s36, v212
    v_mul_f32 v217, s36, v217
    v_mul_f32 v222, s36, v222
    v_exp_f32 v207, v207
    v_exp_f32 v212, v212
    v_exp_f32 v217, v217
    v_exp_f32 v222, v222
    s_nop 0
    v_mul_f32 v4, v207, v171
    v_fmac_f32 v4, v212, v181
    v_fmac_f32 v4, v217, v191
    v_fmac_f32 v4, v222, v201
    v_rcp_f32 v4, v4
    s_nop 0
    v_mul_f32 v207, v207, v4
    v_mul_f32 v212, v212, v4
    v_mul_f32 v217, v217, v4
    v_mul_f32 v222, v222, v4
    v_max3_f32 v3, v172, v182, v192
    v_max_f32 v3, v3, v202
    v_sub_f32 v208, v172, v3
    v_sub_f32 v213, v182, v3
    v_sub_f32 v218, v192, v3
    v_sub_f32 v223, v202, v3
    v_mul_f32 v208, s36, v208
    v_mul_f32 v213, s36, v213
    v_mul_f32 v218, s36, v218
    v_mul_f32 v223, s36, v223
    v_exp_f32 v208, v208
    v_exp_f32 v213, v213
    v_exp_f32 v218, v218
    v_exp_f32 v223, v223
    s_nop 0
    v_mul_f32 v4, v208, v173
    v_fmac_f32 v4, v213, v183
    v_fmac_f32 v4, v218, v193
    v_fmac_f32 v4, v223, v203
    v_rcp_f32 v4, v4
    s_nop 0
    v_mul_f32 v208, v208, v4
    v_mul_f32 v213, v213, v4
    v_mul_f32 v218, v218, v4
    v_mul_f32 v223, v223, v4
    v_accvgpr_read_b32 v224, a8
    v_accvgpr_read_b32 v225, a9
    v_accvgpr_read_b32 v226, a10
    v_accvgpr_read_b32 v227, a11
    s_nop 0
    v_mul_f32 v224, v224, v209
    v_mul_f32 v225, v225, v209
    v_mul_f32 v226, v226, v209
    v_mul_f32 v227, v227, v209
    v_fmac_f32 v224, v44, v204
    v_fmac_f32 v225, v45, v204
    v_fmac_f32 v226, v46, v204
    v_fmac_f32 v227, v47, v204
    v_fmac_f32 v224, v48, v214
    v_fmac_f32 v225, v49, v214
    v_fmac_f32 v226, v50, v214
    v_fmac_f32 v227, v51, v214
    v_fmac_f32 v224, v52, v219
    v_fmac_f32 v225, v53, v219
    v_fmac_f32 v226, v54, v219
    v_fmac_f32 v227, v55, v219
    v_cvt_pk_bf16_f32 v228, v224, v225
    v_cvt_pk_bf16_f32 v229, v226, v227
    buffer_store_dwordx2 v[228:229], v24, s[24:27], 0 offen offset:64
    s_nop 1
    v_accvgpr_read_b32 v224, a40
    v_accvgpr_read_b32 v225, a41
    v_accvgpr_read_b32 v226, a42
    v_accvgpr_read_b32 v227, a43
    s_nop 0
    v_mul_f32 v224, v224, v210
    v_mul_f32 v225, v225, v210
    v_mul_f32 v226, v226, v210
    v_mul_f32 v227, v227, v210
    v_fmac_f32 v224, v56, v205
    v_fmac_f32 v225, v57, v205
    v_fmac_f32 v226, v58, v205
    v_fmac_f32 v227, v59, v205
    v_fmac_f32 v224, v60, v215
    v_fmac_f32 v225, v61, v215
    v_fmac_f32 v226, v62, v215
    v_fmac_f32 v227, v63, v215
    v_fmac_f32 v224, v64, v220
    v_fmac_f32 v225, v65, v220
    v_fmac_f32 v226, v66, v220
    v_fmac_f32 v227, v67, v220
    v_cvt_pk_bf16_f32 v232, v224, v225
    v_cvt_pk_bf16_f32 v233, v226, v227
    s_mov_b32 s29, 4096
    buffer_store_dwordx2 v[232:233], v24, s[24:27], s29 offen offset:64
    s_nop 1
    v_accvgpr_read_b32 v224, a72
    v_accvgpr_read_b32 v225, a73
    v_accvgpr_read_b32 v226, a74
    v_accvgpr_read_b32 v227, a75
    s_nop 0
    v_mul_f32 v224, v224, v211
    v_mul_f32 v225, v225, v211
    v_mul_f32 v226, v226, v211
    v_mul_f32 v227, v227, v211
    v_fmac_f32 v224, v68, v206
    v_fmac_f32 v225, v69, v206
    v_fmac_f32 v226, v70, v206
    v_fmac_f32 v227, v71, v206
    v_fmac_f32 v224, v72, v216
    v_fmac_f32 v225, v73, v216
    v_fmac_f32 v226, v74, v216
    v_fmac_f32 v227, v75, v216
    v_fmac_f32 v224, v76, v221
    v_fmac_f32 v225, v77, v221
    v_fmac_f32 v226, v78, v221
    v_fmac_f32 v227, v79, v221
    v_cvt_pk_bf16_f32 v228, v224, v225
    v_cvt_pk_bf16_f32 v229, v226, v227
    s_mov_b32 s29, 8192
    buffer_store_dwordx2 v[228:229], v24, s[24:27], s29 offen offset:64
    s_nop 1
    v_accvgpr_read_b32 v224, a104
    v_accvgpr_read_b32 v225, a105
    v_accvgpr_read_b32 v226, a106
    v_accvgpr_read_b32 v227, a107
    s_nop 0
    v_mul_f32 v224, v224, v212
    v_mul_f32 v225, v225, v212
    v_mul_f32 v226, v226, v212
    v_mul_f32 v227, v227, v212
    v_fmac_f32 v224, v80, v207
    v_fmac_f32 v225, v81, v207
    v_fmac_f32 v226, v82, v207
    v_fmac_f32 v227, v83, v207
    v_fmac_f32 v224, v84, v217
    v_fmac_f32 v225, v85, v217
    v_fmac_f32 v226, v86, v217
    v_fmac_f32 v227, v87, v217
    v_fmac_f32 v224, v88, v222
    v_fmac_f32 v225, v89, v222
    v_fmac_f32 v226, v90, v222
    v_fmac_f32 v227, v91, v222
    v_cvt_pk_bf16_f32 v232, v224, v225
    v_cvt_pk_bf16_f32 v233, v226, v227
    s_mov_b32 s29, 12288
    buffer_store_dwordx2 v[232:233], v24, s[24:27], s29 offen offset:64
    s_nop 1
    v_accvgpr_read_b32 v224, a136
    v_accvgpr_read_b32 v225, a137
    v_accvgpr_read_b32 v226, a138
    v_accvgpr_read_b32 v227, a139
    s_nop 0
    v_mul_f32 v224, v224, v213
    v_mul_f32 v225, v225, v213
    v_mul_f32 v226, v226, v213
    v_mul_f32 v227, v227, v213
    v_fmac_f32 v224, v92, v208
    v_fmac_f32 v225, v93, v208
    v_fmac_f32 v226, v94, v208
    v_fmac_f32 v227, v95, v208
    v_fmac_f32 v224, v96, v218
    v_fmac_f32 v225, v97, v218
    v_fmac_f32 v226, v98, v218
    v_fmac_f32 v227, v99, v218
    v_fmac_f32 v224, v100, v223
    v_fmac_f32 v225, v101, v223
    v_fmac_f32 v226, v102, v223
    v_fmac_f32 v227, v103, v223
    v_cvt_pk_bf16_f32 v228, v224, v225
    v_cvt_pk_bf16_f32 v229, v226, v227
    s_mov_b32 s29, 16384
    buffer_store_dwordx2 v[228:229], v24, s[24:27], s29 offen offset:64
    s_nop 1
    v_accvgpr_read_b32 v224, a12
    v_accvgpr_read_b32 v225, a13
    v_accvgpr_read_b32 v226, a14
    v_accvgpr_read_b32 v227, a15
    s_nop 0
    v_mul_f32 v224, v224, v209
    v_mul_f32 v225, v225, v209
    v_mul_f32 v226, v226, v209
    v_mul_f32 v227, v227, v209
    v_fmac_f32 v224, v104, v204
    v_fmac_f32 v225, v105, v204
    v_fmac_f32 v226, v106, v204
    v_fmac_f32 v227, v107, v204
    v_fmac_f32 v224, v108, v214
    v_fmac_f32 v225, v109, v214
    v_fmac_f32 v226, v110, v214
    v_fmac_f32 v227, v111, v214
    v_fmac_f32 v224, v112, v219
    v_fmac_f32 v225, v113, v219
    v_fmac_f32 v226, v114, v219
    v_fmac_f32 v227, v115, v219
    v_cvt_pk_bf16_f32 v232, v224, v225
    v_cvt_pk_bf16_f32 v233, v226, v227
    buffer_store_dwordx2 v[232:233], v24, s[24:27], 0 offen offset:96
    s_nop 1
    v_accvgpr_read_b32 v224, a44
    v_accvgpr_read_b32 v225, a45
    v_accvgpr_read_b32 v226, a46
    v_accvgpr_read_b32 v227, a47
    s_nop 0
    v_mul_f32 v224, v224, v210
    v_mul_f32 v225, v225, v210
    v_mul_f32 v226, v226, v210
    v_mul_f32 v227, v227, v210
    v_fmac_f32 v224, v116, v205
    v_fmac_f32 v225, v117, v205
    v_fmac_f32 v226, v118, v205
    v_fmac_f32 v227, v119, v205
    v_fmac_f32 v224, v120, v215
    v_fmac_f32 v225, v121, v215
    v_fmac_f32 v226, v122, v215
    v_fmac_f32 v227, v123, v215
    v_fmac_f32 v224, v124, v220
    v_fmac_f32 v225, v125, v220
    v_fmac_f32 v226, v126, v220
    v_fmac_f32 v227, v127, v220
    v_cvt_pk_bf16_f32 v228, v224, v225
    v_cvt_pk_bf16_f32 v229, v226, v227
    s_mov_b32 s29, 4096
    buffer_store_dwordx2 v[228:229], v24, s[24:27], s29 offen offset:96
    s_nop 1
    v_accvgpr_read_b32 v224, a76
    v_accvgpr_read_b32 v225, a77
    v_accvgpr_read_b32 v226, a78
    v_accvgpr_read_b32 v227, a79
    s_nop 0
    v_mul_f32 v224, v224, v211
    v_mul_f32 v225, v225, v211
    v_mul_f32 v226, v226, v211
    v_mul_f32 v227, v227, v211
    v_fmac_f32 v224, v128, v206
    v_fmac_f32 v225, v129, v206
    v_fmac_f32 v226, v130, v206
    v_fmac_f32 v227, v131, v206
    v_fmac_f32 v224, v132, v216
    v_fmac_f32 v225, v133, v216
    v_fmac_f32 v226, v134, v216
    v_fmac_f32 v227, v135, v216
    v_fmac_f32 v224, v136, v221
    v_fmac_f32 v225, v137, v221
    v_fmac_f32 v226, v138, v221
    v_fmac_f32 v227, v139, v221
    v_cvt_pk_bf16_f32 v232, v224, v225
    v_cvt_pk_bf16_f32 v233, v226, v227
    s_mov_b32 s29, 8192
    buffer_store_dwordx2 v[232:233], v24, s[24:27], s29 offen offset:96
    s_nop 1
    v_accvgpr_read_b32 v224, a108
    v_accvgpr_read_b32 v225, a109
    v_accvgpr_read_b32 v226, a110
    v_accvgpr_read_b32 v227, a111
    s_nop 0
    v_mul_f32 v224, v224, v212
    v_mul_f32 v225, v225, v212
    v_mul_f32 v226, v226, v212
    v_mul_f32 v227, v227, v212
    v_fmac_f32 v224, v140, v207
    v_fmac_f32 v225, v141, v207
    v_fmac_f32 v226, v142, v207
    v_fmac_f32 v227, v143, v207
    v_fmac_f32 v224, v144, v217
    v_fmac_f32 v225, v145, v217
    v_fmac_f32 v226, v146, v217
    v_fmac_f32 v227, v147, v217
    v_fmac_f32 v224, v148, v222
    v_fmac_f32 v225, v149, v222
    v_fmac_f32 v226, v150, v222
    v_fmac_f32 v227, v151, v222
    v_cvt_pk_bf16_f32 v228, v224, v225
    v_cvt_pk_bf16_f32 v229, v226, v227
    s_mov_b32 s29, 12288
    buffer_store_dwordx2 v[228:229], v24, s[24:27], s29 offen offset:96
    s_nop 1
    v_accvgpr_read_b32 v224, a140
    v_accvgpr_read_b32 v225, a141
    v_accvgpr_read_b32 v226, a142
    v_accvgpr_read_b32 v227, a143
    s_nop 0
    v_mul_f32 v224, v224, v213
    v_mul_f32 v225, v225, v213
    v_mul_f32 v226, v226, v213
    v_mul_f32 v227, v227, v213
    v_fmac_f32 v224, v152, v208
    v_fmac_f32 v225, v153, v208
    v_fmac_f32 v226, v154, v208
    v_fmac_f32 v227, v155, v208
    v_fmac_f32 v224, v156, v218
    v_fmac_f32 v225, v157, v218
    v_fmac_f32 v226, v158, v218
    v_fmac_f32 v227, v159, v218
    v_fmac_f32 v224, v160, v223
    v_fmac_f32 v225, v161, v223
    v_fmac_f32 v226, v162, v223
    v_fmac_f32 v227, v163, v223
    v_cvt_pk_bf16_f32 v232, v224, v225
    v_cvt_pk_bf16_f32 v233, v226, v227
    s_mov_b32 s29, 16384
    buffer_store_dwordx2 v[232:233], v24, s[24:27], s29 offen offset:96
    s_nop 1
    s_waitcnt vmcnt(0)
    s_branch L_END
L_EPI2:
    v_add_u32 v152, 65536, v23
    ds_write_b128 v152, a[24:27] offset:0
    ds_write_b128 v152, a[56:59] offset:1024
    ds_write_b128 v152, a[88:91] offset:2048
    ds_write_b128 v152, a[120:123] offset:3072
    ds_write_b128 v152, a[152:155] offset:4096
    ds_write_b128 v152, a[28:31] offset:5120
    ds_write_b128 v152, a[60:63] offset:6144
    ds_write_b128 v152, a[92:95] offset:7168
    ds_write_b128 v152, a[124:127] offset:8192
    ds_write_b128 v152, a[156:159] offset:9216
    ds_write_b128 v152, a[0:3] offset:10240
    ds_write_b128 v152, a[32:35] offset:11264
    ds_write_b128 v152, a[64:67] offset:12288
    ds_write_b128 v152, a[96:99] offset:13312
    ds_write_b128 v152, a[128:131] offset:14336
    ds_write_b128 v152, a[4:7] offset:15360
    ds_write_b128 v152, a[36:39] offset:16384
    ds_write_b128 v152, a[68:71] offset:17408
    ds_write_b128 v152, a[100:103] offset:18432
    ds_write_b128 v152, a[132:135] offset:19456
    ds_write_b128 v152, a[8:11] offset:20480
    ds_write_b128 v152, a[40:43] offset:21504
    ds_write_b128 v152, a[72:75] offset:22528
    ds_write_b128 v152, a[104:107] offset:23552
    ds_write_b128 v152, a[136:139] offset:24576
    ds_write_b128 v152, a[12:15] offset:25600
    ds_write_b128 v152, a[44:47] offset:26624
    ds_write_b128 v152, a[76:79] offset:27648
    ds_write_b128 v152, a[108:111] offset:28672
    ds_write_b128 v152, a[140:143] offset:29696
    s_waitcnt lgkmcnt(0)
    s_barrier
    v_add_u32 v240, 10240, v23
    v_add_u32 v241, 32768, v23
    v_add_u32 v242, 118784, v23
    ds_read_b64 v[164:165], v1 offset:0
    ds_read_b64 v[166:167], v1 offset:128
    ds_read_b64 v[168:169], v1 offset:256
    ds_read_b64 v[170:171], v1 offset:384
    ds_read_b64 v[172:173], v1 offset:512
    ds_read_b64 v[174:175], v1 offset:640
    ds_read_b64 v[176:177], v1 offset:768
    ds_read_b64 v[178:179], v1 offset:896
    ds_read_b64 v[180:181], v1 offset:1024
    ds_read_b64 v[182:183], v1 offset:1152
    ds_read_b64 v[184:185], v1 offset:1280
    ds_read_b64 v[186:187], v1 offset:1408
    ds_read_b64 v[188:189], v1 offset:1536
    ds_read_b64 v[190:191], v1 offset:1664
    ds_read_b64 v[192:193], v1 offset:1792
    ds_read_b64 v[194:195], v1 offset:1920
    ds_read_b64 v[196:197], v1 offset:2048
    ds_read_b64 v[198:199], v1 offset:2176
    ds_read_b64 v[200:201], v1 offset:2304
    ds_read_b64 v[202:203], v1 offset:2432
    ds_read_b128 v[44:47], v240 offset:0
    ds_read_b128 v[48:51], v241 offset:0
    ds_read_b128 v[52:55], v242 offset:0
    ds_read_b128 v[56:59], v240 offset:1024
    ds_read_b128 v[60:63], v241 offset:1024
    ds_read_b128 v[64:67], v242 offset:1024
    ds_read_b128 v[68:71], v240 offset:2048
    ds_read_b128 v[72:75], v241 offset:2048
    ds_read_b128 v[76:79], v242 offset:2048
    ds_read_b128 v[80:83], v240 offset:3072
    ds_read_b128 v[84:87], v241 offset:3072
    ds_read_b128 v[88:91], v242 offset:3072
    ds_read_b128 v[92:95], v240 offset:4096
    ds_read_b128 v[96:99], v241 offset:4096
    ds_read_b128 v[100:103], v242 offset:4096
    ds_read_b128 v[104:107], v240 offset:5120
    ds_read_b128 v[108:111], v241 offset:5120
    ds_read_b128 v[112:115], v242 offset:5120
    ds_read_b128 v[116:119], v240 offset:6144
    ds_read_b128 v[120:123], v241 offset:6144
    ds_read_b128 v[124:127], v242 offset:6144
    ds_read_b128 v[128:131], v240 offset:7168
    ds_read_b128 v[132:135], v241 offset:7168
    ds_read_b128 v[136:139], v242 offset:7168
    ds_read_b128 v[140:143], v240 offset:8192
    ds_read_b128 v[144:147], v241 offset:8192
    ds_read_b128 v[148:151], v242 offset:8192
    ds_read_b128 v[152:155], v240 offset:9216
    ds_read_b128 v[156:159], v241 offset:9216
    ds_read_b128 v[160:163], v242 offset:9216
    s_waitcnt lgkmcnt(15)
    s_waitcnt lgkmcnt(15)
    s_waitcnt lgkmcnt(0)
    v_max3_f32 v3, v164, v174, v184
    v_max_f32 v3, v3, v194
    v_sub_f32 v204, v164, v3
    v_sub_f32 v209, v174, v3
    v_sub_f32 v214, v184, v3
    v_sub_f32 v219, v194, v3
    v_mul_f32 v204, s36, v204
    v_mul_f32 v209, s36, v209
    v_mul_f32 v214, s36, v214
    v_mul_f32 v219, s36, v219
    v_exp_f32 v204, v204
    v_exp_f32 v209, v209
    v_exp_f32 v214, v214
    v_exp_f32 v219, v219
    s_nop 0
    v_mul_f32 v4, v204, v165
    v_fmac_f32 v4, v209, v175
    v_fmac_f32 v4, v214, v185
    v_fmac_f32 v4, v219, v195
    v_rcp_f32 v4, v4
    s_nop 0
    v_mul_f32 v204, v204, v4
    v_mul_f32 v209, v209, v4
    v_mul_f32 v214, v214, v4
    v_mul_f32 v219, v219, v4
    v_max3_f32 v3, v166, v176, v186
    v_max_f32 v3, v3, v196
    v_sub_f32 v205, v166, v3
    v_sub_f32 v210, v176, v3
    v_sub_f32 v215, v186, v3
    v_sub_f32 v220, v196, v3
    v_mul_f32 v205, s36, v205
    v_mul_f32 v210, s36, v210
    v_mul_f32 v215, s36, v215
    v_mul_f32 v220, s36, v220
    v_exp_f32 v205, v205
    v_exp_f32 v210, v210
    v_exp_f32 v215, v215
    v_exp_f32 v220, v220
    s_nop 0
    v_mul_f32 v4, v205, v167
    v_fmac_f32 v4, v210, v177
    v_fmac_f32 v4, v215, v187
    v_fmac_f32 v4, v220, v197
    v_rcp_f32 v4, v4
    s_nop 0
    v_mul_f32 v205, v205, v4
    v_mul_f32 v210, v210, v4
    v_mul_f32 v215, v215, v4
    v_mul_f32 v220, v220, v4
    v_max3_f32 v3, v168, v178, v188
    v_max_f32 v3, v3, v198
    v_sub_f32 v206, v168, v3
    v_sub_f32 v211, v178, v3
    v_sub_f32 v216, v188, v3
    v_sub_f32 v221, v198, v3
    v_mul_f32 v206, s36, v206
    v_mul_f32 v211, s36, v211
    v_mul_f32 v216, s36, v216
    v_mul_f32 v221, s36, v221
    v_exp_f32 v206, v206
    v_exp_f32 v211, v211
    v_exp_f32 v216, v216
    v_exp_f32 v221, v221
    s_nop 0
    v_mul_f32 v4, v206, v169
    v_fmac_f32 v4, v211, v179
    v_fmac_f32 v4, v216, v189
    v_fmac_f32 v4, v221, v199
    v_rcp_f32 v4, v4
    s_nop 0
    v_mul_f32 v206, v206, v4
    v_mul_f32 v211, v211, v4
    v_mul_f32 v216, v216, v4
    v_mul_f32 v221, v221, v4
    v_max3_f32 v3, v170, v180, v190
    v_max_f32 v3, v3, v200
    v_sub_f32 v207, v170, v3
    v_sub_f32 v212, v180, v3
    v_sub_f32 v217, v190, v3
    v_sub_f32 v222, v200, v3
    v_mul_f32 v207, s36, v207
    v_mul_f32 v212, s36, v212
    v_mul_f32 v217, s36, v217
    v_mul_f32 v222, s36, v222
    v_exp_f32 v207, v207
    v_exp_f32 v212, v212
    v_exp_f32 v217, v217
    v_exp_f32 v222, v222
    s_nop 0
    v_mul_f32 v4, v207, v171
    v_fmac_f32 v4, v212, v181
    v_fmac_f32 v4, v217, v191
    v_fmac_f32 v4, v222, v201
    v_rcp_f32 v4, v4
    s_nop 0
    v_mul_f32 v207, v207, v4
    v_mul_f32 v212, v212, v4
    v_mul_f32 v217, v217, v4
    v_mul_f32 v222, v222, v4
    v_max3_f32 v3, v172, v182, v192
    v_max_f32 v3, v3, v202
    v_sub_f32 v208, v172, v3
    v_sub_f32 v213, v182, v3
    v_sub_f32 v218, v192, v3
    v_sub_f32 v223, v202, v3
    v_mul_f32 v208, s36, v208
    v_mul_f32 v213, s36, v213
    v_mul_f32 v218, s36, v218
    v_mul_f32 v223, s36, v223
    v_exp_f32 v208, v208
    v_exp_f32 v213, v213
    v_exp_f32 v218, v218
    v_exp_f32 v223, v223
    s_nop 0
    v_mul_f32 v4, v208, v173
    v_fmac_f32 v4, v213, v183
    v_fmac_f32 v4, v218, v193
    v_fmac_f32 v4, v223, v203
    v_rcp_f32 v4, v4
    s_nop 0
    v_mul_f32 v208, v208, v4
    v_mul_f32 v213, v213, v4
    v_mul_f32 v218, v218, v4
    v_mul_f32 v223, v223, v4
    v_accvgpr_read_b32 v224, a16
    v_accvgpr_read_b32 v225, a17
    v_accvgpr_read_b32 v226, a18
    v_accvgpr_read_b32 v227, a19
    s_nop 0
    v_mul_f32 v224, v224, v214
    v_mul_f32 v225, v225, v214
    v_mul_f32 v226, v226, v214
    v_mul_f32 v227, v227, v214
    v_fmac_f32 v224, v44, v204
    v_fmac_f32 v225, v45, v204
    v_fmac_f32 v226, v46, v204
    v_fmac_f32 v227, v47, v204
    v_fmac_f32 v224, v48, v209
    v_fmac_f32 v225, v49, v209
    v_fmac_f32 v226, v50, v209
    v_fmac_f32 v227, v51, v209
    v_fmac_f32 v224, v52, v219
    v_fmac_f32 v225, v53, v219
    v_fmac_f32 v226, v54, v219
    v_fmac_f32 v227, v55, v219
    v_cvt_pk_bf16_f32 v228, v224, v225
    v_cvt_pk_bf16_f32 v229, v226, v227
    buffer_store_dwordx2 v[228:229], v24, s[24:27], 0 offen offset:128
    s_nop 1
    v_accvgpr_read_b32 v224, a48
    v_accvgpr_read_b32 v225, a49
    v_accvgpr_read_b32 v226, a50
    v_accvgpr_read_b32 v227, a51
    s_nop 0
    v_mul_f32 v224, v224, v215
    v_mul_f32 v225, v225, v215
    v_mul_f32 v226, v226, v215
    v_mul_f32 v227, v227, v215
    v_fmac_f32 v224, v56, v205
    v_fmac_f32 v225, v57, v205
    v_fmac_f32 v226, v58, v205
    v_fmac_f32 v227, v59, v205
    v_fmac_f32 v224, v60, v210
    v_fmac_f32 v225, v61, v210
    v_fmac_f32 v226, v62, v210
    v_fmac_f32 v227, v63, v210
    v_fmac_f32 v224, v64, v220
    v_fmac_f32 v225, v65, v220
    v_fmac_f32 v226, v66, v220
    v_fmac_f32 v227, v67, v220
    v_cvt_pk_bf16_f32 v232, v224, v225
    v_cvt_pk_bf16_f32 v233, v226, v227
    s_mov_b32 s29, 4096
    buffer_store_dwordx2 v[232:233], v24, s[24:27], s29 offen offset:128
    s_nop 1
    v_accvgpr_read_b32 v224, a80
    v_accvgpr_read_b32 v225, a81
    v_accvgpr_read_b32 v226, a82
    v_accvgpr_read_b32 v227, a83
    s_nop 0
    v_mul_f32 v224, v224, v216
    v_mul_f32 v225, v225, v216
    v_mul_f32 v226, v226, v216
    v_mul_f32 v227, v227, v216
    v_fmac_f32 v224, v68, v206
    v_fmac_f32 v225, v69, v206
    v_fmac_f32 v226, v70, v206
    v_fmac_f32 v227, v71, v206
    v_fmac_f32 v224, v72, v211
    v_fmac_f32 v225, v73, v211
    v_fmac_f32 v226, v74, v211
    v_fmac_f32 v227, v75, v211
    v_fmac_f32 v224, v76, v221
    v_fmac_f32 v225, v77, v221
    v_fmac_f32 v226, v78, v221
    v_fmac_f32 v227, v79, v221
    v_cvt_pk_bf16_f32 v228, v224, v225
    v_cvt_pk_bf16_f32 v229, v226, v227
    s_mov_b32 s29, 8192
    buffer_store_dwordx2 v[228:229], v24, s[24:27], s29 offen offset:128
    s_nop 1
    v_accvgpr_read_b32 v224, a112
    v_accvgpr_read_b32 v225, a113
    v_accvgpr_read_b32 v226, a114
    v_accvgpr_read_b32 v227, a115
    s_nop 0
    v_mul_f32 v224, v224, v217
    v_mul_f32 v225, v225, v217
    v_mul_f32 v226, v226, v217
    v_mul_f32 v227, v227, v217
    v_fmac_f32 v224, v80, v207
    v_fmac_f32 v225, v81, v207
    v_fmac_f32 v226, v82, v207
    v_fmac_f32 v227, v83, v207
    v_fmac_f32 v224, v84, v212
    v_fmac_f32 v225, v85, v212
    v_fmac_f32 v226, v86, v212
    v_fmac_f32 v227, v87, v212
    v_fmac_f32 v224, v88, v222
    v_fmac_f32 v225, v89, v222
    v_fmac_f32 v226, v90, v222
    v_fmac_f32 v227, v91, v222
    v_cvt_pk_bf16_f32 v232, v224, v225
    v_cvt_pk_bf16_f32 v233, v226, v227
    s_mov_b32 s29, 12288
    buffer_store_dwordx2 v[232:233], v24, s[24:27], s29 offen offset:128
    s_nop 1
    v_accvgpr_read_b32 v224, a144
    v_accvgpr_read_b32 v225, a145
    v_accvgpr_read_b32 v226, a146
    v_accvgpr_read_b32 v227, a147
    s_nop 0
    v_mul_f32 v224, v224, v218
    v_mul_f32 v225, v225, v218
    v_mul_f32 v226, v226, v218
    v_mul_f32 v227, v227, v218
    v_fmac_f32 v224, v92, v208
    v_fmac_f32 v225, v93, v208
    v_fmac_f32 v226, v94, v208
    v_fmac_f32 v227, v95, v208
    v_fmac_f32 v224, v96, v213
    v_fmac_f32 v225, v97, v213
    v_fmac_f32 v226, v98, v213
    v_fmac_f32 v227, v99, v213
    v_fmac_f32 v224, v100, v223
    v_fmac_f32 v225, v101, v223
    v_fmac_f32 v226, v102, v223
    v_fmac_f32 v227, v103, v223
    v_cvt_pk_bf16_f32 v228, v224, v225
    v_cvt_pk_bf16_f32 v229, v226, v227
    s_mov_b32 s29, 16384
    buffer_store_dwordx2 v[228:229], v24, s[24:27], s29 offen offset:128
    s_nop 1
    v_accvgpr_read_b32 v224, a20
    v_accvgpr_read_b32 v225, a21
    v_accvgpr_read_b32 v226, a22
    v_accvgpr_read_b32 v227, a23
    s_nop 0
    v_mul_f32 v224, v224, v214
    v_mul_f32 v225, v225, v214
    v_mul_f32 v226, v226, v214
    v_mul_f32 v227, v227, v214
    v_fmac_f32 v224, v104, v204
    v_fmac_f32 v225, v105, v204
    v_fmac_f32 v226, v106, v204
    v_fmac_f32 v227, v107, v204
    v_fmac_f32 v224, v108, v209
    v_fmac_f32 v225, v109, v209
    v_fmac_f32 v226, v110, v209
    v_fmac_f32 v227, v111, v209
    v_fmac_f32 v224, v112, v219
    v_fmac_f32 v225, v113, v219
    v_fmac_f32 v226, v114, v219
    v_fmac_f32 v227, v115, v219
    v_cvt_pk_bf16_f32 v232, v224, v225
    v_cvt_pk_bf16_f32 v233, v226, v227
    buffer_store_dwordx2 v[232:233], v24, s[24:27], 0 offen offset:160
    s_nop 1
    v_accvgpr_read_b32 v224, a52
    v_accvgpr_read_b32 v225, a53
    v_accvgpr_read_b32 v226, a54
    v_accvgpr_read_b32 v227, a55
    s_nop 0
    v_mul_f32 v224, v224, v215
    v_mul_f32 v225, v225, v215
    v_mul_f32 v226, v226, v215
    v_mul_f32 v227, v227, v215
    v_fmac_f32 v224, v116, v205
    v_fmac_f32 v225, v117, v205
    v_fmac_f32 v226, v118, v205
    v_fmac_f32 v227, v119, v205
    v_fmac_f32 v224, v120, v210
    v_fmac_f32 v225, v121, v210
    v_fmac_f32 v226, v122, v210
    v_fmac_f32 v227, v123, v210
    v_fmac_f32 v224, v124, v220
    v_fmac_f32 v225, v125, v220
    v_fmac_f32 v226, v126, v220
    v_fmac_f32 v227, v127, v220
    v_cvt_pk_bf16_f32 v228, v224, v225
    v_cvt_pk_bf16_f32 v229, v226, v227
    s_mov_b32 s29, 4096
    buffer_store_dwordx2 v[228:229], v24, s[24:27], s29 offen offset:160
    s_nop 1
    v_accvgpr_read_b32 v224, a84
    v_accvgpr_read_b32 v225, a85
    v_accvgpr_read_b32 v226, a86
    v_accvgpr_read_b32 v227, a87
    s_nop 0
    v_mul_f32 v224, v224, v216
    v_mul_f32 v225, v225, v216
    v_mul_f32 v226, v226, v216
    v_mul_f32 v227, v227, v216
    v_fmac_f32 v224, v128, v206
    v_fmac_f32 v225, v129, v206
    v_fmac_f32 v226, v130, v206
    v_fmac_f32 v227, v131, v206
    v_fmac_f32 v224, v132, v211
    v_fmac_f32 v225, v133, v211
    v_fmac_f32 v226, v134, v211
    v_fmac_f32 v227, v135, v211
    v_fmac_f32 v224, v136, v221
    v_fmac_f32 v225, v137, v221
    v_fmac_f32 v226, v138, v221
    v_fmac_f32 v227, v139, v221
    v_cvt_pk_bf16_f32 v232, v224, v225
    v_cvt_pk_bf16_f32 v233, v226, v227
    s_mov_b32 s29, 8192
    buffer_store_dwordx2 v[232:233], v24, s[24:27], s29 offen offset:160
    s_nop 1
    v_accvgpr_read_b32 v224, a116
    v_accvgpr_read_b32 v225, a117
    v_accvgpr_read_b32 v226, a118
    v_accvgpr_read_b32 v227, a119
    s_nop 0
    v_mul_f32 v224, v224, v217
    v_mul_f32 v225, v225, v217
    v_mul_f32 v226, v226, v217
    v_mul_f32 v227, v227, v217
    v_fmac_f32 v224, v140, v207
    v_fmac_f32 v225, v141, v207
    v_fmac_f32 v226, v142, v207
    v_fmac_f32 v227, v143, v207
    v_fmac_f32 v224, v144, v212
    v_fmac_f32 v225, v145, v212
    v_fmac_f32 v226, v146, v212
    v_fmac_f32 v227, v147, v212
    v_fmac_f32 v224, v148, v222
    v_fmac_f32 v225, v149, v222
    v_fmac_f32 v226, v150, v222
    v_fmac_f32 v227, v151, v222
    v_cvt_pk_bf16_f32 v228, v224, v225
    v_cvt_pk_bf16_f32 v229, v226, v227
    s_mov_b32 s29, 12288
    buffer_store_dwordx2 v[228:229], v24, s[24:27], s29 offen offset:160
    s_nop 1
    v_accvgpr_read_b32 v224, a148
    v_accvgpr_read_b32 v225, a149
    v_accvgpr_read_b32 v226, a150
    v_accvgpr_read_b32 v227, a151
    s_nop 0
    v_mul_f32 v224, v224, v218
    v_mul_f32 v225, v225, v218
    v_mul_f32 v226, v226, v218
    v_mul_f32 v227, v227, v218
    v_fmac_f32 v224, v152, v208
    v_fmac_f32 v225, v153, v208
    v_fmac_f32 v226, v154, v208
    v_fmac_f32 v227, v155, v208
    v_fmac_f32 v224, v156, v213
    v_fmac_f32 v225, v157, v213
    v_fmac_f32 v226, v158, v213
    v_fmac_f32 v227, v159, v213
    v_fmac_f32 v224, v160, v223
    v_fmac_f32 v225, v161, v223
    v_fmac_f32 v226, v162, v223
    v_fmac_f32 v227, v163, v223
    v_cvt_pk_bf16_f32 v232, v224, v225
    v_cvt_pk_bf16_f32 v233, v226, v227
    s_mov_b32 s29, 16384
    buffer_store_dwordx2 v[232:233], v24, s[24:27], s29 offen offset:160
    s_nop 1
    s_waitcnt vmcnt(0)
    s_branch L_END
L_EPI3:
    v_add_u32 v152, 98304, v23
    ds_write_b128 v152, a[0:3] offset:0
    ds_write_b128 v152, a[32:35] offset:1024
    ds_write_b128 v152, a[64:67] offset:2048
    ds_write_b128 v152, a[96:99] offset:3072
    ds_write_b128 v152, a[128:131] offset:4096
    ds_write_b128 v152, a[4:7] offset:5120
    ds_write_b128 v152, a[36:39] offset:6144
    ds_write_b128 v152, a[68:71] offset:7168
    ds_write_b128 v152, a[100:103] offset:8192
    ds_write_b128 v152, a[132:135] offset:9216
    ds_write_b128 v152, a[8:11] offset:10240
    ds_write_b128 v152, a[40:43] offset:11264
    ds_write_b128 v152, a[72:75] offset:12288
    ds_write_b128 v152, a[104:107] offset:13312
    ds_write_b128 v152, a[136:139] offset:14336
    ds_write_b128 v152, a[12:15] offset:15360
    ds_write_b128 v152, a[44:47] offset:16384
    ds_write_b128 v152, a[76:79] offset:17408
    ds_write_b128 v152, a[108:111] offset:18432
    ds_write_b128 v152, a[140:143] offset:19456
    ds_write_b128 v152, a[16:19] offset:20480
    ds_write_b128 v152, a[48:51] offset:21504
    ds_write_b128 v152, a[80:83] offset:22528
    ds_write_b128 v152, a[112:115] offset:23552
    ds_write_b128 v152, a[144:147] offset:24576
    ds_write_b128 v152, a[20:23] offset:25600
    ds_write_b128 v152, a[52:55] offset:26624
    ds_write_b128 v152, a[84:87] offset:27648
    ds_write_b128 v152, a[116:119] offset:28672
    ds_write_b128 v152, a[148:151] offset:29696
    s_waitcnt lgkmcnt(0)
    s_barrier
    v_add_u32 v240, 20480, v23
    v_add_u32 v241, 43008, v23
    v_add_u32 v242, 65536, v23
    ds_read_b64 v[164:165], v1 offset:0
    ds_read_b64 v[166:167], v1 offset:128
    ds_read_b64 v[168:169], v1 offset:256
    ds_read_b64 v[170:171], v1 offset:384
    ds_read_b64 v[172:173], v1 offset:512
    ds_read_b64 v[174:175], v1 offset:640
    ds_read_b64 v[176:177], v1 offset:768
    ds_read_b64 v[178:179], v1 offset:896
    ds_read_b64 v[180:181], v1 offset:1024
    ds_read_b64 v[182:183], v1 offset:1152
    ds_read_b64 v[184:185], v1 offset:1280
    ds_read_b64 v[186:187], v1 offset:1408
    ds_read_b64 v[188:189], v1 offset:1536
    ds_read_b64 v[190:191], v1 offset:1664
    ds_read_b64 v[192:193], v1 offset:1792
    ds_read_b64 v[194:195], v1 offset:1920
    ds_read_b64 v[196:197], v1 offset:2048
    ds_read_b64 v[198:199], v1 offset:2176
    ds_read_b64 v[200:201], v1 offset:2304
    ds_read_b64 v[202:203], v1 offset:2432
    ds_read_b128 v[44:47], v240 offset:0
    ds_read_b128 v[48:51], v241 offset:0
    ds_read_b128 v[52:55], v242 offset:0
    ds_read_b128 v[56:59], v240 offset:1024
    ds_read_b128 v[60:63], v241 offset:1024
    ds_read_b128 v[64:67], v242 offset:1024
    ds_read_b128 v[68:71], v240 offset:2048
    ds_read_b128 v[72:75], v241 offset:2048
    ds_read_b128 v[76:79], v242 offset:2048
    ds_read_b128 v[80:83], v240 offset:3072
    ds_read_b128 v[84:87], v241 offset:3072
    ds_read_b128 v[88:91], v242 offset:3072
    ds_read_b128 v[92:95], v240 offset:4096
    ds_read_b128 v[96:99], v241 offset:4096
    ds_read_b128 v[100:103], v242 offset:4096
    ds_read_b128 v[104:107], v240 offset:5120
    ds_read_b128 v[108:111], v241 offset:5120
    ds_read_b128 v[112:115], v242 offset:5120
    ds_read_b128 v[116:119], v240 offset:6144
    ds_read_b128 v[120:123], v241 offset:6144
    ds_read_b128 v[124:127], v242 offset:6144
    ds_read_b128 v[128:131], v240 offset:7168
    ds_read_b128 v[132:135], v241 offset:7168
    ds_read_b128 v[136:139], v242 offset:7168
    ds_read_b128 v[140:143], v240 offset:8192
    ds_read_b128 v[144:147], v241 offset:8192
    ds_read_b128 v[148:151], v242 offset:8192
    ds_read_b128 v[152:155], v240 offset:9216
    ds_read_b128 v[156:159], v241 offset:9216
    ds_read_b128 v[160:163], v242 offset:9216
    s_waitcnt lgkmcnt(15)
    s_waitcnt lgkmcnt(15)
    s_waitcnt lgkmcnt(0)
    v_max3_f32 v3, v164, v174, v184
    v_max_f32 v3, v3, v194
    v_sub_f32 v204, v164, v3
    v_sub_f32 v209, v174, v3
    v_sub_f32 v214, v184, v3
    v_sub_f32 v219, v194, v3
    v_mul_f32 v204, s36, v204
    v_mul_f32 v209, s36, v209
    v_mul_f32 v214, s36, v214
    v_mul_f32 v219, s36, v219
    v_exp_f32 v204, v204
    v_exp_f32 v209, v209
    v_exp_f32 v214, v214
    v_exp_f32 v219, v219
    s_nop 0
    v_mul_f32 v4, v204, v165
    v_fmac_f32 v4, v209, v175
    v_fmac_f32 v4, v214, v185
    v_fmac_f32 v4, v219, v195
    v_rcp_f32 v4, v4
    s_nop 0
    v_mul_f32 v204, v204, v4
    v_mul_f32 v209, v209, v4
    v_mul_f32 v214, v214, v4
    v_mul_f32 v219, v219, v4
    v_max3_f32 v3, v166, v176, v186
    v_max_f32 v3, v3, v196
    v_sub_f32 v205, v166, v3
    v_sub_f32 v210, v176, v3
    v_sub_f32 v215, v186, v3
    v_sub_f32 v220, v196, v3
    v_mul_f32 v205, s36, v205
    v_mul_f32 v210, s36, v210
    v_mul_f32 v215, s36, v215
    v_mul_f32 v220, s36, v220
    v_exp_f32 v205, v205
    v_exp_f32 v210, v210
    v_exp_f32 v215, v215
    v_exp_f32 v220, v220
    s_nop 0
    v_mul_f32 v4, v205, v167
    v_fmac_f32 v4, v210, v177
    v_fmac_f32 v4, v215, v187
    v_fmac_f32 v4, v220, v197
    v_rcp_f32 v4, v4
    s_nop 0
    v_mul_f32 v205, v205, v4
    v_mul_f32 v210, v210, v4
    v_mul_f32 v215, v215, v4
    v_mul_f32 v220, v220, v4
    v_max3_f32 v3, v168, v178, v188
    v_max_f32 v3, v3, v198
    v_sub_f32 v206, v168, v3
    v_sub_f32 v211, v178, v3
    v_sub_f32 v216, v188, v3
    v_sub_f32 v221, v198, v3
    v_mul_f32 v206, s36, v206
    v_mul_f32 v211, s36, v211
    v_mul_f32 v216, s36, v216
    v_mul_f32 v221, s36, v221
    v_exp_f32 v206, v206
    v_exp_f32 v211, v211
    v_exp_f32 v216, v216
    v_exp_f32 v221, v221
    s_nop 0
    v_mul_f32 v4, v206, v169
    v_fmac_f32 v4, v211, v179
    v_fmac_f32 v4, v216, v189
    v_fmac_f32 v4, v221, v199
    v_rcp_f32 v4, v4
    s_nop 0
    v_mul_f32 v206, v206, v4
    v_mul_f32 v211, v211, v4
    v_mul_f32 v216, v216, v4
    v_mul_f32 v221, v221, v4
    v_max3_f32 v3, v170, v180, v190
    v_max_f32 v3, v3, v200
    v_sub_f32 v207, v170, v3
    v_sub_f32 v212, v180, v3
    v_sub_f32 v217, v190, v3
    v_sub_f32 v222, v200, v3
    v_mul_f32 v207, s36, v207
    v_mul_f32 v212, s36, v212
    v_mul_f32 v217, s36, v217
    v_mul_f32 v222, s36, v222
    v_exp_f32 v207, v207
    v_exp_f32 v212, v212
    v_exp_f32 v217, v217
    v_exp_f32 v222, v222
    s_nop 0
    v_mul_f32 v4, v207, v171
    v_fmac_f32 v4, v212, v181
    v_fmac_f32 v4, v217, v191
    v_fmac_f32 v4, v222, v201
    v_rcp_f32 v4, v4
    s_nop 0
    v_mul_f32 v207, v207, v4
    v_mul_f32 v212, v212, v4
    v_mul_f32 v217, v217, v4
    v_mul_f32 v222, v222, v4
    v_max3_f32 v3, v172, v182, v192
    v_max_f32 v3, v3, v202
    v_sub_f32 v208, v172, v3
    v_sub_f32 v213, v182, v3
    v_sub_f32 v218, v192, v3
    v_sub_f32 v223, v202, v3
    v_mul_f32 v208, s36, v208
    v_mul_f32 v213, s36, v213
    v_mul_f32 v218, s36, v218
    v_mul_f32 v223, s36, v223
    v_exp_f32 v208, v208
    v_exp_f32 v213, v213
    v_exp_f32 v218, v218
    v_exp_f32 v223, v223
    s_nop 0
    v_mul_f32 v4, v208, v173
    v_fmac_f32 v4, v213, v183
    v_fmac_f32 v4, v218, v193
    v_fmac_f32 v4, v223, v203
    v_rcp_f32 v4, v4
    s_nop 0
    v_mul_f32 v208, v208, v4
    v_mul_f32 v213, v213, v4
    v_mul_f32 v218, v218, v4
    v_mul_f32 v223, v223, v4
    v_accvgpr_read_b32 v224, a24
    v_accvgpr_read_b32 v225, a25
    v_accvgpr_read_b32 v226, a26
    v_accvgpr_read_b32 v227, a27
    s_nop 0
    v_mul_f32 v224, v224, v219
    v_mul_f32 v225, v225, v219
    v_mul_f32 v226, v226, v219
    v_mul_f32 v227, v227, v219
    v_fmac_f32 v224, v44, v204
    v_fmac_f32 v225, v45, v204
    v_fmac_f32 v226, v46, v204
    v_fmac_f32 v227, v47, v204
    v_fmac_f32 v224, v48, v209
    v_fmac_f32 v225, v49, v209
    v_fmac_f32 v226, v50, v209
    v_fmac_f32 v227, v51, v209
    v_fmac_f32 v224, v52, v214
    v_fmac_f32 v225, v53, v214
    v_fmac_f32 v226, v54, v214
    v_fmac_f32 v227, v55, v214
    v_cvt_pk_bf16_f32 v228, v224, v225
    v_cvt_pk_bf16_f32 v229, v226, v227
    buffer_store_dwordx2 v[228:229], v24, s[24:27], 0 offen offset:192
    s_nop 1
    v_accvgpr_read_b32 v224, a56
    v_accvgpr_read_b32 v225, a57
    v_accvgpr_read_b32 v226, a58
    v_accvgpr_read_b32 v227, a59
    s_nop 0
    v_mul_f32 v224, v224, v220
    v_mul_f32 v225, v225, v220
    v_mul_f32 v226, v226, v220
    v_mul_f32 v227, v227, v220
    v_fmac_f32 v224, v56, v205
    v_fmac_f32 v225, v57, v205
    v_fmac_f32 v226, v58, v205
    v_fmac_f32 v227, v59, v205
    v_fmac_f32 v224, v60, v210
    v_fmac_f32 v225, v61, v210
    v_fmac_f32 v226, v62, v210
    v_fmac_f32 v227, v63, v210
    v_fmac_f32 v224, v64, v215
    v_fmac_f32 v225, v65, v215
    v_fmac_f32 v226, v66, v215
    v_fmac_f32 v227, v67, v215
    v_cvt_pk_bf16_f32 v232, v224, v225
    v_cvt_pk_bf16_f32 v233, v226, v227
    s_mov_b32 s29, 4096
    buffer_store_dwordx2 v[232:233], v24, s[24:27], s29 offen offset:192
    s_nop 1
    v_accvgpr_read_b32 v224, a88
    v_accvgpr_read_b32 v225, a89
    v_accvgpr_read_b32 v226, a90
    v_accvgpr_read_b32 v227, a91
    s_nop 0
    v_mul_f32 v224, v224, v221
    v_mul_f32 v225, v225, v221
    v_mul_f32 v226, v226, v221
    v_mul_f32 v227, v227, v221
    v_fmac_f32 v224, v68, v206
    v_fmac_f32 v225, v69, v206
    v_fmac_f32 v226, v70, v206
    v_fmac_f32 v227, v71, v206
    v_fmac_f32 v224, v72, v211
    v_fmac_f32 v225, v73, v211
    v_fmac_f32 v226, v74, v211
    v_fmac_f32 v227, v75, v211
    v_fmac_f32 v224, v76, v216
    v_fmac_f32 v225, v77, v216
    v_fmac_f32 v226, v78, v216
    v_fmac_f32 v227, v79, v216
    v_cvt_pk_bf16_f32 v228, v224, v225
    v_cvt_pk_bf16_f32 v229, v226, v227
    s_mov_b32 s29, 8192
    buffer_store_dwordx2 v[228:229], v24, s[24:27], s29 offen offset:192
    s_nop 1
    v_accvgpr_read_b32 v224, a120
    v_accvgpr_read_b32 v225, a121
    v_accvgpr_read_b32 v226, a122
    v_accvgpr_read_b32 v227, a123
    s_nop 0
    v_mul_f32 v224, v224, v222
    v_mul_f32 v225, v225, v222
    v_mul_f32 v226, v226, v222
    v_mul_f32 v227, v227, v222
    v_fmac_f32 v224, v80, v207
    v_fmac_f32 v225, v81, v207
    v_fmac_f32 v226, v82, v207
    v_fmac_f32 v227, v83, v207
    v_fmac_f32 v224, v84, v212
    v_fmac_f32 v225, v85, v212
    v_fmac_f32 v226, v86, v212
    v_fmac_f32 v227, v87, v212
    v_fmac_f32 v224, v88, v217
    v_fmac_f32 v225, v89, v217
    v_fmac_f32 v226, v90, v217
    v_fmac_f32 v227, v91, v217
    v_cvt_pk_bf16_f32 v232, v224, v225
    v_cvt_pk_bf16_f32 v233, v226, v227
    s_mov_b32 s29, 12288
    buffer_store_dwordx2 v[232:233], v24, s[24:27], s29 offen offset:192
    s_nop 1
    v_accvgpr_read_b32 v224, a152
    v_accvgpr_read_b32 v225, a153
    v_accvgpr_read_b32 v226, a154
    v_accvgpr_read_b32 v227, a155
    s_nop 0
    v_mul_f32 v224, v224, v223
    v_mul_f32 v225, v225, v223
    v_mul_f32 v226, v226, v223
    v_mul_f32 v227, v227, v223
    v_fmac_f32 v224, v92, v208
    v_fmac_f32 v225, v93, v208
    v_fmac_f32 v226, v94, v208
    v_fmac_f32 v227, v95, v208
    v_fmac_f32 v224, v96, v213
    v_fmac_f32 v225, v97, v213
    v_fmac_f32 v226, v98, v213
    v_fmac_f32 v227, v99, v213
    v_fmac_f32 v224, v100, v218
    v_fmac_f32 v225, v101, v218
    v_fmac_f32 v226, v102, v218
    v_fmac_f32 v227, v103, v218
    v_cvt_pk_bf16_f32 v228, v224, v225
    v_cvt_pk_bf16_f32 v229, v226, v227
    s_mov_b32 s29, 16384
    buffer_store_dwordx2 v[228:229], v24, s[24:27], s29 offen offset:192
    s_nop 1
    v_accvgpr_read_b32 v224, a28
    v_accvgpr_read_b32 v225, a29
    v_accvgpr_read_b32 v226, a30
    v_accvgpr_read_b32 v227, a31
    s_nop 0
    v_mul_f32 v224, v224, v219
    v_mul_f32 v225, v225, v219
    v_mul_f32 v226, v226, v219
    v_mul_f32 v227, v227, v219
    v_fmac_f32 v224, v104, v204
    v_fmac_f32 v225, v105, v204
    v_fmac_f32 v226, v106, v204
    v_fmac_f32 v227, v107, v204
    v_fmac_f32 v224, v108, v209
    v_fmac_f32 v225, v109, v209
    v_fmac_f32 v226, v110, v209
    v_fmac_f32 v227, v111, v209
    v_fmac_f32 v224, v112, v214
    v_fmac_f32 v225, v113, v214
    v_fmac_f32 v226, v114, v214
    v_fmac_f32 v227, v115, v214
    v_cvt_pk_bf16_f32 v232, v224, v225
    v_cvt_pk_bf16_f32 v233, v226, v227
    buffer_store_dwordx2 v[232:233], v24, s[24:27], 0 offen offset:224
    s_nop 1
    v_accvgpr_read_b32 v224, a60
    v_accvgpr_read_b32 v225, a61
    v_accvgpr_read_b32 v226, a62
    v_accvgpr_read_b32 v227, a63
    s_nop 0
    v_mul_f32 v224, v224, v220
    v_mul_f32 v225, v225, v220
    v_mul_f32 v226, v226, v220
    v_mul_f32 v227, v227, v220
    v_fmac_f32 v224, v116, v205
    v_fmac_f32 v225, v117, v205
    v_fmac_f32 v226, v118, v205
    v_fmac_f32 v227, v119, v205
    v_fmac_f32 v224, v120, v210
    v_fmac_f32 v225, v121, v210
    v_fmac_f32 v226, v122, v210
    v_fmac_f32 v227, v123, v210
    v_fmac_f32 v224, v124, v215
    v_fmac_f32 v225, v125, v215
    v_fmac_f32 v226, v126, v215
    v_fmac_f32 v227, v127, v215
    v_cvt_pk_bf16_f32 v228, v224, v225
    v_cvt_pk_bf16_f32 v229, v226, v227
    s_mov_b32 s29, 4096
    buffer_store_dwordx2 v[228:229], v24, s[24:27], s29 offen offset:224
    s_nop 1
    v_accvgpr_read_b32 v224, a92
    v_accvgpr_read_b32 v225, a93
    v_accvgpr_read_b32 v226, a94
    v_accvgpr_read_b32 v227, a95
    s_nop 0
    v_mul_f32 v224, v224, v221
    v_mul_f32 v225, v225, v221
    v_mul_f32 v226, v226, v221
    v_mul_f32 v227, v227, v221
    v_fmac_f32 v224, v128, v206
    v_fmac_f32 v225, v129, v206
    v_fmac_f32 v226, v130, v206
    v_fmac_f32 v227, v131, v206
    v_fmac_f32 v224, v132, v211
    v_fmac_f32 v225, v133, v211
    v_fmac_f32 v226, v134, v211
    v_fmac_f32 v227, v135, v211
    v_fmac_f32 v224, v136, v216
    v_fmac_f32 v225, v137, v216
    v_fmac_f32 v226, v138, v216
    v_fmac_f32 v227, v139, v216
    v_cvt_pk_bf16_f32 v232, v224, v225
    v_cvt_pk_bf16_f32 v233, v226, v227
    s_mov_b32 s29, 8192
    buffer_store_dwordx2 v[232:233], v24, s[24:27], s29 offen offset:224
    s_nop 1
    v_accvgpr_read_b32 v224, a124
    v_accvgpr_read_b32 v225, a125
    v_accvgpr_read_b32 v226, a126
    v_accvgpr_read_b32 v227, a127
    s_nop 0
    v_mul_f32 v224, v224, v222
    v_mul_f32 v225, v225, v222
    v_mul_f32 v226, v226, v222
    v_mul_f32 v227, v227, v222
    v_fmac_f32 v224, v140, v207
    v_fmac_f32 v225, v141, v207
    v_fmac_f32 v226, v142, v207
    v_fmac_f32 v227, v143, v207
    v_fmac_f32 v224, v144, v212
    v_fmac_f32 v225, v145, v212
    v_fmac_f32 v226, v146, v212
    v_fmac_f32 v227, v147, v212
    v_fmac_f32 v224, v148, v217
    v_fmac_f32 v225, v149, v217
    v_fmac_f32 v226, v150, v217
    v_fmac_f32 v227, v151, v217
    v_cvt_pk_bf16_f32 v228, v224, v225
    v_cvt_pk_bf16_f32 v229, v226, v227
    s_mov_b32 s29, 12288
    buffer_store_dwordx2 v[228:229], v24, s[24:27], s29 offen offset:224
    s_nop 1
    v_accvgpr_read_b32 v224, a156
    v_accvgpr_read_b32 v225, a157
    v_accvgpr_read_b32 v226, a158
    v_accvgpr_read_b32 v227, a159
    s_nop 0
    v_mul_f32 v224, v224, v223
    v_mul_f32 v225, v225, v223
    v_mul_f32 v226, v226, v223
    v_mul_f32 v227, v227, v223
    v_fmac_f32 v224, v152, v208
    v_fmac_f32 v225, v153, v208
    v_fmac_f32 v226, v154, v208
    v_fmac_f32 v227, v155, v208
    v_fmac_f32 v224, v156, v213
    v_fmac_f32 v225, v157, v213
    v_fmac_f32 v226, v158, v213
    v_fmac_f32 v227, v159, v213
    v_fmac_f32 v224, v160, v218
    v_fmac_f32 v225, v161, v218
    v_fmac_f32 v226, v162, v218
    v_fmac_f32 v227, v163, v218
    v_cvt_pk_bf16_f32 v232, v224, v225
    v_cvt_pk_bf16_f32 v233, v226, v227
    s_mov_b32 s29, 16384
    buffer_store_dwordx2 v[232:233], v24, s[24:27], s29 offen offset:224
    s_nop 1
    s_waitcnt vmcnt(0)
L_END:
    s_endpgm
SLOW_0_0:
    v_mov_b32 v3, v1
    s_nop 1
    v_permlane16_swap_b32 v1, v3
    s_nop 0
    v_max_f32 v1, v1, v3
    v_mov_b32 v3, v1
    s_nop 1
    v_permlane32_swap_b32 v1, v3
    s_nop 0
    v_max_f32 v1, v1, v3
    v_max_f32 v4, v25, v1
    v_sub_f32 v5, v25, v4
    v_mul_f32 v5, s36, v5
    v_exp_f32 v5, v5
    v_mov_b32 v25, v4
    v_add_f32 v30, 0x427af232, v4
    v_mul_f32 v35, 0xbe0293ee, v4
    s_cmp_lg_u32 s37, 0
    s_cbranch_scc1 RET_0_0
    s_nop 7
    v_accvgpr_read_b32 v6, a0
    v_accvgpr_read_b32 v7, a1
    v_accvgpr_read_b32 v8, a2
    v_accvgpr_read_b32 v9, a3
    s_nop 0
    v_mul_f32 v6, v6, v5
    v_mul_f32 v7, v7, v5
    v_mul_f32 v8, v8, v5
    v_mul_f32 v9, v9, v5
    s_nop 0
    v_accvgpr_write_b32 a0, v6
    v_accvgpr_write_b32 a1, v7
    v_accvgpr_write_b32 a2, v8
    v_accvgpr_write_b32 a3, v9
    s_nop 0
    v_accvgpr_read_b32 v6, a4
    v_accvgpr_read_b32 v7, a5
    v_accvgpr_read_b32 v8, a6
    v_accvgpr_read_b32 v9, a7
    s_nop 0
    v_mul_f32 v6, v6, v5
    v_mul_f32 v7, v7, v5
    v_mul_f32 v8, v8, v5
    v_mul_f32 v9, v9, v5
    s_nop 0
    v_accvgpr_write_b32 a4, v6
    v_accvgpr_write_b32 a5, v7
    v_accvgpr_write_b32 a6, v8
    v_accvgpr_write_b32 a7, v9
    s_nop 0
    v_accvgpr_read_b32 v6, a8
    v_accvgpr_read_b32 v7, a9
    v_accvgpr_read_b32 v8, a10
    v_accvgpr_read_b32 v9, a11
    s_nop 0
    v_mul_f32 v6, v6, v5
    v_mul_f32 v7, v7, v5
    v_mul_f32 v8, v8, v5
    v_mul_f32 v9, v9, v5
    s_nop 0
    v_accvgpr_write_b32 a8, v6
    v_accvgpr_write_b32 a9, v7
    v_accvgpr_write_b32 a10, v8
    v_accvgpr_write_b32 a11, v9
    s_nop 0
    v_accvgpr_read_b32 v6, a12
    v_accvgpr_read_b32 v7, a13
    v_accvgpr_read_b32 v8, a14
    v_accvgpr_read_b32 v9, a15
    s_nop 0
    v_mul_f32 v6, v6, v5
    v_mul_f32 v7, v7, v5
    v_mul_f32 v8, v8, v5
    v_mul_f32 v9, v9, v5
    s_nop 0
    v_accvgpr_write_b32 a12, v6
    v_accvgpr_write_b32 a13, v7
    v_accvgpr_write_b32 a14, v8
    v_accvgpr_write_b32 a15, v9
    s_nop 0
    v_accvgpr_read_b32 v6, a16
    v_accvgpr_read_b32 v7, a17
    v_accvgpr_read_b32 v8, a18
    v_accvgpr_read_b32 v9, a19
    s_nop 0
    v_mul_f32 v6, v6, v5
    v_mul_f32 v7, v7, v5
    v_mul_f32 v8, v8, v5
    v_mul_f32 v9, v9, v5
    s_nop 0
    v_accvgpr_write_b32 a16, v6
    v_accvgpr_write_b32 a17, v7
    v_accvgpr_write_b32 a18, v8
    v_accvgpr_write_b32 a19, v9
    s_nop 0
    v_accvgpr_read_b32 v6, a20
    v_accvgpr_read_b32 v7, a21
    v_accvgpr_read_b32 v8, a22
    v_accvgpr_read_b32 v9, a23
    s_nop 0
    v_mul_f32 v6, v6, v5
    v_mul_f32 v7, v7, v5
    v_mul_f32 v8, v8, v5
    v_mul_f32 v9, v9, v5
    s_nop 0
    v_accvgpr_write_b32 a20, v6
    v_accvgpr_write_b32 a21, v7
    v_accvgpr_write_b32 a22, v8
    v_accvgpr_write_b32 a23, v9
    s_nop 0
    v_accvgpr_read_b32 v6, a24
    v_accvgpr_read_b32 v7, a25
    v_accvgpr_read_b32 v8, a26
    v_accvgpr_read_b32 v9, a27
    s_nop 0
    v_mul_f32 v6, v6, v5
    v_mul_f32 v7, v7, v5
    v_mul_f32 v8, v8, v5
    v_mul_f32 v9, v9, v5
    s_nop 0
    v_accvgpr_write_b32 a24, v6
    v_accvgpr_write_b32 a25, v7
    v_accvgpr_write_b32 a26, v8
    v_accvgpr_write_b32 a27, v9
    s_nop 0
    v_accvgpr_read_b32 v6, a28
    v_accvgpr_read_b32 v7, a29
    v_accvgpr_read_b32 v8, a30
    v_accvgpr_read_b32 v9, a31
    s_nop 0
    v_mul_f32 v6, v6, v5
    v_mul_f32 v7, v7, v5
    v_mul_f32 v8, v8, v5
    v_mul_f32 v9, v9, v5
    s_nop 0
    v_accvgpr_write_b32 a28, v6
    v_accvgpr_write_b32 a29, v7
    v_accvgpr_write_b32 a30, v8
    v_accvgpr_write_b32 a31, v9
    s_nop 0
    v_mul_f32 v68, v68, v5
    v_mul_f32 v69, v69, v5
    v_mul_f32 v70, v70, v5
    v_mul_f32 v71, v71, v5
    s_nop 1
    s_branch RET_0_0
SLOW_0_1:
    v_mov_b32 v3, v1
    s_nop 1
    v_permlane16_swap_b32 v1, v3
    s_nop 0
    v_max_f32 v1, v1, v3
    v_mov_b32 v3, v1
    s_nop 1
    v_permlane32_swap_b32 v1, v3
    s_nop 0
    v_max_f32 v1, v1, v3
    v_max_f32 v4, v26, v1
    v_sub_f32 v5, v26, v4
    v_mul_f32 v5, s36, v5
    v_exp_f32 v5, v5
    v_mov_b32 v26, v4
    v_add_f32 v31, 0x427af232, v4
    v_mul_f32 v36, 0xbe0293ee, v4
    s_cmp_lg_u32 s37, 0
    s_cbranch_scc1 RET_0_1
    s_nop 7
    v_accvgpr_read_b32 v6, a32
    v_accvgpr_read_b32 v7, a33
    v_accvgpr_read_b32 v8, a34
    v_accvgpr_read_b32 v9, a35
    s_nop 0
    v_mul_f32 v6, v6, v5
    v_mul_f32 v7, v7, v5
    v_mul_f32 v8, v8, v5
    v_mul_f32 v9, v9, v5
    s_nop 0
    v_accvgpr_write_b32 a32, v6
    v_accvgpr_write_b32 a33, v7
    v_accvgpr_write_b32 a34, v8
    v_accvgpr_write_b32 a35, v9
    s_nop 0
    v_accvgpr_read_b32 v6, a36
    v_accvgpr_read_b32 v7, a37
    v_accvgpr_read_b32 v8, a38
    v_accvgpr_read_b32 v9, a39
    s_nop 0
    v_mul_f32 v6, v6, v5
    v_mul_f32 v7, v7, v5
    v_mul_f32 v8, v8, v5
    v_mul_f32 v9, v9, v5
    s_nop 0
    v_accvgpr_write_b32 a36, v6
    v_accvgpr_write_b32 a37, v7
    v_accvgpr_write_b32 a38, v8
    v_accvgpr_write_b32 a39, v9
    s_nop 0
    v_accvgpr_read_b32 v6, a40
    v_accvgpr_read_b32 v7, a41
    v_accvgpr_read_b32 v8, a42
    v_accvgpr_read_b32 v9, a43
    s_nop 0
    v_mul_f32 v6, v6, v5
    v_mul_f32 v7, v7, v5
    v_mul_f32 v8, v8, v5
    v_mul_f32 v9, v9, v5
    s_nop 0
    v_accvgpr_write_b32 a40, v6
    v_accvgpr_write_b32 a41, v7
    v_accvgpr_write_b32 a42, v8
    v_accvgpr_write_b32 a43, v9
    s_nop 0
    v_accvgpr_read_b32 v6, a44
    v_accvgpr_read_b32 v7, a45
    v_accvgpr_read_b32 v8, a46
    v_accvgpr_read_b32 v9, a47
    s_nop 0
    v_mul_f32 v6, v6, v5
    v_mul_f32 v7, v7, v5
    v_mul_f32 v8, v8, v5
    v_mul_f32 v9, v9, v5
    s_nop 0
    v_accvgpr_write_b32 a44, v6
    v_accvgpr_write_b32 a45, v7
    v_accvgpr_write_b32 a46, v8
    v_accvgpr_write_b32 a47, v9
    s_nop 0
    v_accvgpr_read_b32 v6, a48
    v_accvgpr_read_b32 v7, a49
    v_accvgpr_read_b32 v8, a50
    v_accvgpr_read_b32 v9, a51
    s_nop 0
    v_mul_f32 v6, v6, v5
    v_mul_f32 v7, v7, v5
    v_mul_f32 v8, v8, v5
    v_mul_f32 v9, v9, v5
    s_nop 0
    v_accvgpr_write_b32 a48, v6
    v_accvgpr_write_b32 a49, v7
    v_accvgpr_write_b32 a50, v8
    v_accvgpr_write_b32 a51, v9
    s_nop 0
    v_accvgpr_read_b32 v6, a52
    v_accvgpr_read_b32 v7, a53
    v_accvgpr_read_b32 v8, a54
    v_accvgpr_read_b32 v9, a55
    s_nop 0
    v_mul_f32 v6, v6, v5
    v_mul_f32 v7, v7, v5
    v_mul_f32 v8, v8, v5
    v_mul_f32 v9, v9, v5
    s_nop 0
    v_accvgpr_write_b32 a52, v6
    v_accvgpr_write_b32 a53, v7
    v_accvgpr_write_b32 a54, v8
    v_accvgpr_write_b32 a55, v9
    s_nop 0
    v_accvgpr_read_b32 v6, a56
    v_accvgpr_read_b32 v7, a57
    v_accvgpr_read_b32 v8, a58
    v_accvgpr_read_b32 v9, a59
    s_nop 0
    v_mul_f32 v6, v6, v5
    v_mul_f32 v7, v7, v5
    v_mul_f32 v8, v8, v5
    v_mul_f32 v9, v9, v5
    s_nop 0
    v_accvgpr_write_b32 a56, v6
    v_accvgpr_write_b32 a57, v7
    v_accvgpr_write_b32 a58, v8
    v_accvgpr_write_b32 a59, v9
    s_nop 0
    v_accvgpr_read_b32 v6, a60
    v_accvgpr_read_b32 v7, a61
    v_accvgpr_read_b32 v8, a62
    v_accvgpr_read_b32 v9, a63
    s_nop 0
    v_mul_f32 v6, v6, v5
    v_mul_f32 v7, v7, v5
    v_mul_f32 v8, v8, v5
    v_mul_f32 v9, v9, v5
    s_nop 0
    v_accvgpr_write_b32 a60, v6
    v_accvgpr_write_b32 a61, v7
    v_accvgpr_write_b32 a62, v8
    v_accvgpr_write_b32 a63, v9
    s_nop 0
    v_mul_f32 v72, v72, v5
    v_mul_f32 v73, v73, v5
    v_mul_f32 v74, v74, v5
    v_mul_f32 v75, v75, v5
    s_nop 1
    s_branch RET_0_1
SLOW_0_2:
    v_mov_b32 v3, v1
    s_nop 1
    v_permlane16_swap_b32 v1, v3
    s_nop 0
    v_max_f32 v1, v1, v3
    v_mov_b32 v3, v1
    s_nop 1
    v_permlane32_swap_b32 v1, v3
    s_nop 0
    v_max_f32 v1, v1, v3
    v_max_f32 v4, v27, v1
    v_sub_f32 v5, v27, v4
    v_mul_f32 v5, s36, v5
    v_exp_f32 v5, v5
    v_mov_b32 v27, v4
    v_add_f32 v32, 0x427af232, v4
    v_mul_f32 v37, 0xbe0293ee, v4
    s_cmp_lg_u32 s37, 0
    s_cbranch_scc1 RET_0_2
    s_nop 7
    v_accvgpr_read_b32 v6, a64
    v_accvgpr_read_b32 v7, a65
    v_accvgpr_read_b32 v8, a66
    v_accvgpr_read_b32 v9, a67
    s_nop 0
    v_mul_f32 v6, v6, v5
    v_mul_f32 v7, v7, v5
    v_mul_f32 v8, v8, v5
    v_mul_f32 v9, v9, v5
    s_nop 0
    v_accvgpr_write_b32 a64, v6
    v_accvgpr_write_b32 a65, v7
    v_accvgpr_write_b32 a66, v8
    v_accvgpr_write_b32 a67, v9
    s_nop 0
    v_accvgpr_read_b32 v6, a68
    v_accvgpr_read_b32 v7, a69
    v_accvgpr_read_b32 v8, a70
    v_accvgpr_read_b32 v9, a71
    s_nop 0
    v_mul_f32 v6, v6, v5
    v_mul_f32 v7, v7, v5
    v_mul_f32 v8, v8, v5
    v_mul_f32 v9, v9, v5
    s_nop 0
    v_accvgpr_write_b32 a68, v6
    v_accvgpr_write_b32 a69, v7
    v_accvgpr_write_b32 a70, v8
    v_accvgpr_write_b32 a71, v9
    s_nop 0
    v_accvgpr_read_b32 v6, a72
    v_accvgpr_read_b32 v7, a73
    v_accvgpr_read_b32 v8, a74
    v_accvgpr_read_b32 v9, a75
    s_nop 0
    v_mul_f32 v6, v6, v5
    v_mul_f32 v7, v7, v5
    v_mul_f32 v8, v8, v5
    v_mul_f32 v9, v9, v5
    s_nop 0
    v_accvgpr_write_b32 a72, v6
    v_accvgpr_write_b32 a73, v7
    v_accvgpr_write_b32 a74, v8
    v_accvgpr_write_b32 a75, v9
    s_nop 0
    v_accvgpr_read_b32 v6, a76
    v_accvgpr_read_b32 v7, a77
    v_accvgpr_read_b32 v8, a78
    v_accvgpr_read_b32 v9, a79
    s_nop 0
    v_mul_f32 v6, v6, v5
    v_mul_f32 v7, v7, v5
    v_mul_f32 v8, v8, v5
    v_mul_f32 v9, v9, v5
    s_nop 0
    v_accvgpr_write_b32 a76, v6
    v_accvgpr_write_b32 a77, v7
    v_accvgpr_write_b32 a78, v8
    v_accvgpr_write_b32 a79, v9
    s_nop 0
    v_accvgpr_read_b32 v6, a80
    v_accvgpr_read_b32 v7, a81
    v_accvgpr_read_b32 v8, a82
    v_accvgpr_read_b32 v9, a83
    s_nop 0
    v_mul_f32 v6, v6, v5
    v_mul_f32 v7, v7, v5
    v_mul_f32 v8, v8, v5
    v_mul_f32 v9, v9, v5
    s_nop 0
    v_accvgpr_write_b32 a80, v6
    v_accvgpr_write_b32 a81, v7
    v_accvgpr_write_b32 a82, v8
    v_accvgpr_write_b32 a83, v9
    s_nop 0
    v_accvgpr_read_b32 v6, a84
    v_accvgpr_read_b32 v7, a85
    v_accvgpr_read_b32 v8, a86
    v_accvgpr_read_b32 v9, a87
    s_nop 0
    v_mul_f32 v6, v6, v5
    v_mul_f32 v7, v7, v5
    v_mul_f32 v8, v8, v5
    v_mul_f32 v9, v9, v5
    s_nop 0
    v_accvgpr_write_b32 a84, v6
    v_accvgpr_write_b32 a85, v7
    v_accvgpr_write_b32 a86, v8
    v_accvgpr_write_b32 a87, v9
    s_nop 0
    v_accvgpr_read_b32 v6, a88
    v_accvgpr_read_b32 v7, a89
    v_accvgpr_read_b32 v8, a90
    v_accvgpr_read_b32 v9, a91
    s_nop 0
    v_mul_f32 v6, v6, v5
    v_mul_f32 v7, v7, v5
    v_mul_f32 v8, v8, v5
    v_mul_f32 v9, v9, v5
    s_nop 0
    v_accvgpr_write_b32 a88, v6
    v_accvgpr_write_b32 a89, v7
    v_accvgpr_write_b32 a90, v8
    v_accvgpr_write_b32 a91, v9
    s_nop 0
    v_accvgpr_read_b32 v6, a92
    v_accvgpr_read_b32 v7, a93
    v_accvgpr_read_b32 v8, a94
    v_accvgpr_read_b32 v9, a95
    s_nop 0
    v_mul_f32 v6, v6, v5
    v_mul_f32 v7, v7, v5
    v_mul_f32 v8, v8, v5
    v_mul_f32 v9, v9, v5
    s_nop 0
    v_accvgpr_write_b32 a92, v6
    v_accvgpr_write_b32 a93, v7
    v_accvgpr_write_b32 a94, v8
    v_accvgpr_write_b32 a95, v9
    s_nop 0
    v_mul_f32 v76, v76, v5
    v_mul_f32 v77, v77, v5
    v_mul_f32 v78, v78, v5
    v_mul_f32 v79, v79, v5
    s_nop 1
    s_branch RET_0_2
SLOW_0_3:
    v_mov_b32 v3, v1
    s_nop 1
    v_permlane16_swap_b32 v1, v3
    s_nop 0
    v_max_f32 v1, v1, v3
    v_mov_b32 v3, v1
    s_nop 1
    v_permlane32_swap_b32 v1, v3
    s_nop 0
    v_max_f32 v1, v1, v3
    v_max_f32 v4, v28, v1
    v_sub_f32 v5, v28, v4
    v_mul_f32 v5, s36, v5
    v_exp_f32 v5, v5
    v_mov_b32 v28, v4
    v_add_f32 v33, 0x427af232, v4
    v_mul_f32 v38, 0xbe0293ee, v4
    s_cmp_lg_u32 s37, 0
    s_cbranch_scc1 RET_0_3
    s_nop 7
    v_accvgpr_read_b32 v6, a96
    v_accvgpr_read_b32 v7, a97
    v_accvgpr_read_b32 v8, a98
    v_accvgpr_read_b32 v9, a99
    s_nop 0
    v_mul_f32 v6, v6, v5
    v_mul_f32 v7, v7, v5
    v_mul_f32 v8, v8, v5
    v_mul_f32 v9, v9, v5
    s_nop 0
    v_accvgpr_write_b32 a96, v6
    v_accvgpr_write_b32 a97, v7
    v_accvgpr_write_b32 a98, v8
    v_accvgpr_write_b32 a99, v9
    s_nop 0
    v_accvgpr_read_b32 v6, a100
    v_accvgpr_read_b32 v7, a101
    v_accvgpr_read_b32 v8, a102
    v_accvgpr_read_b32 v9, a103
    s_nop 0
    v_mul_f32 v6, v6, v5
    v_mul_f32 v7, v7, v5
    v_mul_f32 v8, v8, v5
    v_mul_f32 v9, v9, v5
    s_nop 0
    v_accvgpr_write_b32 a100, v6
    v_accvgpr_write_b32 a101, v7
    v_accvgpr_write_b32 a102, v8
    v_accvgpr_write_b32 a103, v9
    s_nop 0
    v_accvgpr_read_b32 v6, a104
    v_accvgpr_read_b32 v7, a105
    v_accvgpr_read_b32 v8, a106
    v_accvgpr_read_b32 v9, a107
    s_nop 0
    v_mul_f32 v6, v6, v5
    v_mul_f32 v7, v7, v5
    v_mul_f32 v8, v8, v5
    v_mul_f32 v9, v9, v5
    s_nop 0
    v_accvgpr_write_b32 a104, v6
    v_accvgpr_write_b32 a105, v7
    v_accvgpr_write_b32 a106, v8
    v_accvgpr_write_b32 a107, v9
    s_nop 0
    v_accvgpr_read_b32 v6, a108
    v_accvgpr_read_b32 v7, a109
    v_accvgpr_read_b32 v8, a110
    v_accvgpr_read_b32 v9, a111
    s_nop 0
    v_mul_f32 v6, v6, v5
    v_mul_f32 v7, v7, v5
    v_mul_f32 v8, v8, v5
    v_mul_f32 v9, v9, v5
    s_nop 0
    v_accvgpr_write_b32 a108, v6
    v_accvgpr_write_b32 a109, v7
    v_accvgpr_write_b32 a110, v8
    v_accvgpr_write_b32 a111, v9
    s_nop 0
    v_accvgpr_read_b32 v6, a112
    v_accvgpr_read_b32 v7, a113
    v_accvgpr_read_b32 v8, a114
    v_accvgpr_read_b32 v9, a115
    s_nop 0
    v_mul_f32 v6, v6, v5
    v_mul_f32 v7, v7, v5
    v_mul_f32 v8, v8, v5
    v_mul_f32 v9, v9, v5
    s_nop 0
    v_accvgpr_write_b32 a112, v6
    v_accvgpr_write_b32 a113, v7
    v_accvgpr_write_b32 a114, v8
    v_accvgpr_write_b32 a115, v9
    s_nop 0
    v_accvgpr_read_b32 v6, a116
    v_accvgpr_read_b32 v7, a117
    v_accvgpr_read_b32 v8, a118
    v_accvgpr_read_b32 v9, a119
    s_nop 0
    v_mul_f32 v6, v6, v5
    v_mul_f32 v7, v7, v5
    v_mul_f32 v8, v8, v5
    v_mul_f32 v9, v9, v5
    s_nop 0
    v_accvgpr_write_b32 a116, v6
    v_accvgpr_write_b32 a117, v7
    v_accvgpr_write_b32 a118, v8
    v_accvgpr_write_b32 a119, v9
    s_nop 0
    v_accvgpr_read_b32 v6, a120
    v_accvgpr_read_b32 v7, a121
    v_accvgpr_read_b32 v8, a122
    v_accvgpr_read_b32 v9, a123
    s_nop 0
    v_mul_f32 v6, v6, v5
    v_mul_f32 v7, v7, v5
    v_mul_f32 v8, v8, v5
    v_mul_f32 v9, v9, v5
    s_nop 0
    v_accvgpr_write_b32 a120, v6
    v_accvgpr_write_b32 a121, v7
    v_accvgpr_write_b32 a122, v8
    v_accvgpr_write_b32 a123, v9
    s_nop 0
    v_accvgpr_read_b32 v6, a124
    v_accvgpr_read_b32 v7, a125
    v_accvgpr_read_b32 v8, a126
    v_accvgpr_read_b32 v9, a127
    s_nop 0
    v_mul_f32 v6, v6, v5
    v_mul_f32 v7, v7, v5
    v_mul_f32 v8, v8, v5
    v_mul_f32 v9, v9, v5
    s_nop 0
    v_accvgpr_write_b32 a124, v6
    v_accvgpr_write_b32 a125, v7
    v_accvgpr_write_b32 a126, v8
    v_accvgpr_write_b32 a127, v9
    s_nop 0
    v_mul_f32 v80, v80, v5
    v_mul_f32 v81, v81, v5
    v_mul_f32 v82, v82, v5
    v_mul_f32 v83, v83, v5
    s_nop 1
    s_branch RET_0_3
SLOW_0_4:
    v_mov_b32 v3, v1
    s_nop 1
    v_permlane16_swap_b32 v1, v3
    s_nop 0
    v_max_f32 v1, v1, v3
    v_mov_b32 v3, v1
    s_nop 1
    v_permlane32_swap_b32 v1, v3
    s_nop 0
    v_max_f32 v1, v1, v3
    v_max_f32 v4, v29, v1
    v_sub_f32 v5, v29, v4
    v_mul_f32 v5, s36, v5
    v_exp_f32 v5, v5
    v_mov_b32 v29, v4
    v_add_f32 v34, 0x427af232, v4
    v_mul_f32 v39, 0xbe0293ee, v4
    s_cmp_lg_u32 s37, 0
    s_cbranch_scc1 RET_0_4
    s_nop 7
    v_accvgpr_read_b32 v6, a128
    v_accvgpr_read_b32 v7, a129
    v_accvgpr_read_b32 v8, a130
    v_accvgpr_read_b32 v9, a131
    s_nop 0
    v_mul_f32 v6, v6, v5
    v_mul_f32 v7, v7, v5
    v_mul_f32 v8, v8, v5
    v_mul_f32 v9, v9, v5
    s_nop 0
    v_accvgpr_write_b32 a128, v6
    v_accvgpr_write_b32 a129, v7
    v_accvgpr_write_b32 a130, v8
    v_accvgpr_write_b32 a131, v9
    s_nop 0
    v_accvgpr_read_b32 v6, a132
    v_accvgpr_read_b32 v7, a133
    v_accvgpr_read_b32 v8, a134
    v_accvgpr_read_b32 v9, a135
    s_nop 0
    v_mul_f32 v6, v6, v5
    v_mul_f32 v7, v7, v5
    v_mul_f32 v8, v8, v5
    v_mul_f32 v9, v9, v5
    s_nop 0
    v_accvgpr_write_b32 a132, v6
    v_accvgpr_write_b32 a133, v7
    v_accvgpr_write_b32 a134, v8
    v_accvgpr_write_b32 a135, v9
    s_nop 0
    v_accvgpr_read_b32 v6, a136
    v_accvgpr_read_b32 v7, a137
    v_accvgpr_read_b32 v8, a138
    v_accvgpr_read_b32 v9, a139
    s_nop 0
    v_mul_f32 v6, v6, v5
    v_mul_f32 v7, v7, v5
    v_mul_f32 v8, v8, v5
    v_mul_f32 v9, v9, v5
    s_nop 0
    v_accvgpr_write_b32 a136, v6
    v_accvgpr_write_b32 a137, v7
    v_accvgpr_write_b32 a138, v8
    v_accvgpr_write_b32 a139, v9
    s_nop 0
    v_accvgpr_read_b32 v6, a140
    v_accvgpr_read_b32 v7, a141
    v_accvgpr_read_b32 v8, a142
    v_accvgpr_read_b32 v9, a143
    s_nop 0
    v_mul_f32 v6, v6, v5
    v_mul_f32 v7, v7, v5
    v_mul_f32 v8, v8, v5
    v_mul_f32 v9, v9, v5
    s_nop 0
    v_accvgpr_write_b32 a140, v6
    v_accvgpr_write_b32 a141, v7
    v_accvgpr_write_b32 a142, v8
    v_accvgpr_write_b32 a143, v9
    s_nop 0
    v_accvgpr_read_b32 v6, a144
    v_accvgpr_read_b32 v7, a145
    v_accvgpr_read_b32 v8, a146
    v_accvgpr_read_b32 v9, a147
    s_nop 0
    v_mul_f32 v6, v6, v5
    v_mul_f32 v7, v7, v5
    v_mul_f32 v8, v8, v5
    v_mul_f32 v9, v9, v5
    s_nop 0
    v_accvgpr_write_b32 a144, v6
    v_accvgpr_write_b32 a145, v7
    v_accvgpr_write_b32 a146, v8
    v_accvgpr_write_b32 a147, v9
    s_nop 0
    v_accvgpr_read_b32 v6, a148
    v_accvgpr_read_b32 v7, a149
    v_accvgpr_read_b32 v8, a150
    v_accvgpr_read_b32 v9, a151
    s_nop 0
    v_mul_f32 v6, v6, v5
    v_mul_f32 v7, v7, v5
    v_mul_f32 v8, v8, v5
    v_mul_f32 v9, v9, v5
    s_nop 0
    v_accvgpr_write_b32 a148, v6
    v_accvgpr_write_b32 a149, v7
    v_accvgpr_write_b32 a150, v8
    v_accvgpr_write_b32 a151, v9
    s_nop 0
    v_accvgpr_read_b32 v6, a152
    v_accvgpr_read_b32 v7, a153
    v_accvgpr_read_b32 v8, a154
    v_accvgpr_read_b32 v9, a155
    s_nop 0
    v_mul_f32 v6, v6, v5
    v_mul_f32 v7, v7, v5
    v_mul_f32 v8, v8, v5
    v_mul_f32 v9, v9, v5
    s_nop 0
    v_accvgpr_write_b32 a152, v6
    v_accvgpr_write_b32 a153, v7
    v_accvgpr_write_b32 a154, v8
    v_accvgpr_write_b32 a155, v9
    s_nop 0
    v_accvgpr_read_b32 v6, a156
    v_accvgpr_read_b32 v7, a157
    v_accvgpr_read_b32 v8, a158
    v_accvgpr_read_b32 v9, a159
    s_nop 0
    v_mul_f32 v6, v6, v5
    v_mul_f32 v7, v7, v5
    v_mul_f32 v8, v8, v5
    v_mul_f32 v9, v9, v5
    s_nop 0
    v_accvgpr_write_b32 a156, v6
    v_accvgpr_write_b32 a157, v7
    v_accvgpr_write_b32 a158, v8
    v_accvgpr_write_b32 a159, v9
    s_nop 0
    v_mul_f32 v84, v84, v5
    v_mul_f32 v85, v85, v5
    v_mul_f32 v86, v86, v5
    v_mul_f32 v87, v87, v5
    s_nop 1
    s_branch RET_0_4
SLOW_1_0:
    v_mov_b32 v3, v1
    s_nop 1
    v_permlane16_swap_b32 v1, v3
    s_nop 0
    v_max_f32 v1, v1, v3
    v_mov_b32 v3, v1
    s_nop 1
    v_permlane32_swap_b32 v1, v3
    s_nop 0
    v_max_f32 v1, v1, v3
    v_max_f32 v4, v25, v1
    v_sub_f32 v5, v25, v4
    v_mul_f32 v5, s36, v5
    v_exp_f32 v5, v5
    v_mov_b32 v25, v4
    v_add_f32 v30, 0x427af232, v4
    v_mul_f32 v35, 0xbe0293ee, v4
    s_cmp_lg_u32 s37, 0
    s_cbranch_scc1 RET_1_0
    s_nop 7
    v_accvgpr_read_b32 v6, a0
    v_accvgpr_read_b32 v7, a1
    v_accvgpr_read_b32 v8, a2
    v_accvgpr_read_b32 v9, a3
    s_nop 0
    v_mul_f32 v6, v6, v5
    v_mul_f32 v7, v7, v5
    v_mul_f32 v8, v8, v5
    v_mul_f32 v9, v9, v5
    s_nop 0
    v_accvgpr_write_b32 a0, v6
    v_accvgpr_write_b32 a1, v7
    v_accvgpr_write_b32 a2, v8
    v_accvgpr_write_b32 a3, v9
    s_nop 0
    v_accvgpr_read_b32 v6, a4
    v_accvgpr_read_b32 v7, a5
    v_accvgpr_read_b32 v8, a6
    v_accvgpr_read_b32 v9, a7
    s_nop 0
    v_mul_f32 v6, v6, v5
    v_mul_f32 v7, v7, v5
    v_mul_f32 v8, v8, v5
    v_mul_f32 v9, v9, v5
    s_nop 0
    v_accvgpr_write_b32 a4, v6
    v_accvgpr_write_b32 a5, v7
    v_accvgpr_write_b32 a6, v8
    v_accvgpr_write_b32 a7, v9
    s_nop 0
    v_accvgpr_read_b32 v6, a8
    v_accvgpr_read_b32 v7, a9
    v_accvgpr_read_b32 v8, a10
    v_accvgpr_read_b32 v9, a11
    s_nop 0
    v_mul_f32 v6, v6, v5
    v_mul_f32 v7, v7, v5
    v_mul_f32 v8, v8, v5
    v_mul_f32 v9, v9, v5
    s_nop 0
    v_accvgpr_write_b32 a8, v6
    v_accvgpr_write_b32 a9, v7
    v_accvgpr_write_b32 a10, v8
    v_accvgpr_write_b32 a11, v9
    s_nop 0
    v_accvgpr_read_b32 v6, a12
    v_accvgpr_read_b32 v7, a13
    v_accvgpr_read_b32 v8, a14
    v_accvgpr_read_b32 v9, a15
    s_nop 0
    v_mul_f32 v6, v6, v5
    v_mul_f32 v7, v7, v5
    v_mul_f32 v8, v8, v5
    v_mul_f32 v9, v9, v5
    s_nop 0
    v_accvgpr_write_b32 a12, v6
    v_accvgpr_write_b32 a13, v7
    v_accvgpr_write_b32 a14, v8
    v_accvgpr_write_b32 a15, v9
    s_nop 0
    v_accvgpr_read_b32 v6, a16
    v_accvgpr_read_b32 v7, a17
    v_accvgpr_read_b32 v8, a18
    v_accvgpr_read_b32 v9, a19
    s_nop 0
    v_mul_f32 v6, v6, v5
    v_mul_f32 v7, v7, v5
    v_mul_f32 v8, v8, v5
    v_mul_f32 v9, v9, v5
    s_nop 0
    v_accvgpr_write_b32 a16, v6
    v_accvgpr_write_b32 a17, v7
    v_accvgpr_write_b32 a18, v8
    v_accvgpr_write_b32 a19, v9
    s_nop 0
    v_accvgpr_read_b32 v6, a20
    v_accvgpr_read_b32 v7, a21
    v_accvgpr_read_b32 v8, a22
    v_accvgpr_read_b32 v9, a23
    s_nop 0
    v_mul_f32 v6, v6, v5
    v_mul_f32 v7, v7, v5
    v_mul_f32 v8, v8, v5
    v_mul_f32 v9, v9, v5
    s_nop 0
    v_accvgpr_write_b32 a20, v6
    v_accvgpr_write_b32 a21, v7
    v_accvgpr_write_b32 a22, v8
    v_accvgpr_write_b32 a23, v9
    s_nop 0
    v_accvgpr_read_b32 v6, a24
    v_accvgpr_read_b32 v7, a25
    v_accvgpr_read_b32 v8, a26
    v_accvgpr_read_b32 v9, a27
    s_nop 0
    v_mul_f32 v6, v6, v5
    v_mul_f32 v7, v7, v5
    v_mul_f32 v8, v8, v5
    v_mul_f32 v9, v9, v5
    s_nop 0
    v_accvgpr_write_b32 a24, v6
    v_accvgpr_write_b32 a25, v7
    v_accvgpr_write_b32 a26, v8
    v_accvgpr_write_b32 a27, v9
    s_nop 0
    v_accvgpr_read_b32 v6, a28
    v_accvgpr_read_b32 v7, a29
    v_accvgpr_read_b32 v8, a30
    v_accvgpr_read_b32 v9, a31
    s_nop 0
    v_mul_f32 v6, v6, v5
    v_mul_f32 v7, v7, v5
    v_mul_f32 v8, v8, v5
    v_mul_f32 v9, v9, v5
    s_nop 0
    v_accvgpr_write_b32 a28, v6
    v_accvgpr_write_b32 a29, v7
    v_accvgpr_write_b32 a30, v8
    v_accvgpr_write_b32 a31, v9
    s_nop 0
    v_mul_f32 v68, v68, v5
    v_mul_f32 v69, v69, v5
    v_mul_f32 v70, v70, v5
    v_mul_f32 v71, v71, v5
    s_nop 1
    s_branch RET_1_0
SLOW_1_1:
    v_mov_b32 v3, v1
    s_nop 1
    v_permlane16_swap_b32 v1, v3
    s_nop 0
    v_max_f32 v1, v1, v3
    v_mov_b32 v3, v1
    s_nop 1
    v_permlane32_swap_b32 v1, v3
    s_nop 0
    v_max_f32 v1, v1, v3
    v_max_f32 v4, v26, v1
    v_sub_f32 v5, v26, v4
    v_mul_f32 v5, s36, v5
    v_exp_f32 v5, v5
    v_mov_b32 v26, v4
    v_add_f32 v31, 0x427af232, v4
    v_mul_f32 v36, 0xbe0293ee, v4
    s_cmp_lg_u32 s37, 0
    s_cbranch_scc1 RET_1_1
    s_nop 7
    v_accvgpr_read_b32 v6, a32
    v_accvgpr_read_b32 v7, a33
    v_accvgpr_read_b32 v8, a34
    v_accvgpr_read_b32 v9, a35
    s_nop 0
    v_mul_f32 v6, v6, v5
    v_mul_f32 v7, v7, v5
    v_mul_f32 v8, v8, v5
    v_mul_f32 v9, v9, v5
    s_nop 0
    v_accvgpr_write_b32 a32, v6
    v_accvgpr_write_b32 a33, v7
    v_accvgpr_write_b32 a34, v8
    v_accvgpr_write_b32 a35, v9
    s_nop 0
    v_accvgpr_read_b32 v6, a36
    v_accvgpr_read_b32 v7, a37
    v_accvgpr_read_b32 v8, a38
    v_accvgpr_read_b32 v9, a39
    s_nop 0
    v_mul_f32 v6, v6, v5
    v_mul_f32 v7, v7, v5
    v_mul_f32 v8, v8, v5
    v_mul_f32 v9, v9, v5
    s_nop 0
    v_accvgpr_write_b32 a36, v6
    v_accvgpr_write_b32 a37, v7
    v_accvgpr_write_b32 a38, v8
    v_accvgpr_write_b32 a39, v9
    s_nop 0
    v_accvgpr_read_b32 v6, a40
    v_accvgpr_read_b32 v7, a41
    v_accvgpr_read_b32 v8, a42
    v_accvgpr_read_b32 v9, a43
    s_nop 0
    v_mul_f32 v6, v6, v5
    v_mul_f32 v7, v7, v5
    v_mul_f32 v8, v8, v5
    v_mul_f32 v9, v9, v5
    s_nop 0
    v_accvgpr_write_b32 a40, v6
    v_accvgpr_write_b32 a41, v7
    v_accvgpr_write_b32 a42, v8
    v_accvgpr_write_b32 a43, v9
    s_nop 0
    v_accvgpr_read_b32 v6, a44
    v_accvgpr_read_b32 v7, a45
    v_accvgpr_read_b32 v8, a46
    v_accvgpr_read_b32 v9, a47
    s_nop 0
    v_mul_f32 v6, v6, v5
    v_mul_f32 v7, v7, v5
    v_mul_f32 v8, v8, v5
    v_mul_f32 v9, v9, v5
    s_nop 0
    v_accvgpr_write_b32 a44, v6
    v_accvgpr_write_b32 a45, v7
    v_accvgpr_write_b32 a46, v8
    v_accvgpr_write_b32 a47, v9
    s_nop 0
    v_accvgpr_read_b32 v6, a48
    v_accvgpr_read_b32 v7, a49
    v_accvgpr_read_b32 v8, a50
    v_accvgpr_read_b32 v9, a51
    s_nop 0
    v_mul_f32 v6, v6, v5
    v_mul_f32 v7, v7, v5
    v_mul_f32 v8, v8, v5
    v_mul_f32 v9, v9, v5
    s_nop 0
    v_accvgpr_write_b32 a48, v6
    v_accvgpr_write_b32 a49, v7
    v_accvgpr_write_b32 a50, v8
    v_accvgpr_write_b32 a51, v9
    s_nop 0
    v_accvgpr_read_b32 v6, a52
    v_accvgpr_read_b32 v7, a53
    v_accvgpr_read_b32 v8, a54
    v_accvgpr_read_b32 v9, a55
    s_nop 0
    v_mul_f32 v6, v6, v5
    v_mul_f32 v7, v7, v5
    v_mul_f32 v8, v8, v5
    v_mul_f32 v9, v9, v5
    s_nop 0
    v_accvgpr_write_b32 a52, v6
    v_accvgpr_write_b32 a53, v7
    v_accvgpr_write_b32 a54, v8
    v_accvgpr_write_b32 a55, v9
    s_nop 0
    v_accvgpr_read_b32 v6, a56
    v_accvgpr_read_b32 v7, a57
    v_accvgpr_read_b32 v8, a58
    v_accvgpr_read_b32 v9, a59
    s_nop 0
    v_mul_f32 v6, v6, v5
    v_mul_f32 v7, v7, v5
    v_mul_f32 v8, v8, v5
    v_mul_f32 v9, v9, v5
    s_nop 0
    v_accvgpr_write_b32 a56, v6
    v_accvgpr_write_b32 a57, v7
    v_accvgpr_write_b32 a58, v8
    v_accvgpr_write_b32 a59, v9
    s_nop 0
    v_accvgpr_read_b32 v6, a60
    v_accvgpr_read_b32 v7, a61
    v_accvgpr_read_b32 v8, a62
    v_accvgpr_read_b32 v9, a63
    s_nop 0
    v_mul_f32 v6, v6, v5
    v_mul_f32 v7, v7, v5
    v_mul_f32 v8, v8, v5
    v_mul_f32 v9, v9, v5
    s_nop 0
    v_accvgpr_write_b32 a60, v6
    v_accvgpr_write_b32 a61, v7
    v_accvgpr_write_b32 a62, v8
    v_accvgpr_write_b32 a63, v9
    s_nop 0
    v_mul_f32 v72, v72, v5
    v_mul_f32 v73, v73, v5
    v_mul_f32 v74, v74, v5
    v_mul_f32 v75, v75, v5
    s_nop 1
    s_branch RET_1_1
SLOW_1_2:
    v_mov_b32 v3, v1
    s_nop 1
    v_permlane16_swap_b32 v1, v3
    s_nop 0
    v_max_f32 v1, v1, v3
    v_mov_b32 v3, v1
    s_nop 1
    v_permlane32_swap_b32 v1, v3
    s_nop 0
    v_max_f32 v1, v1, v3
    v_max_f32 v4, v27, v1
    v_sub_f32 v5, v27, v4
    v_mul_f32 v5, s36, v5
    v_exp_f32 v5, v5
    v_mov_b32 v27, v4
    v_add_f32 v32, 0x427af232, v4
    v_mul_f32 v37, 0xbe0293ee, v4
    s_cmp_lg_u32 s37, 0
    s_cbranch_scc1 RET_1_2
    s_nop 7
    v_accvgpr_read_b32 v6, a64
    v_accvgpr_read_b32 v7, a65
    v_accvgpr_read_b32 v8, a66
    v_accvgpr_read_b32 v9, a67
    s_nop 0
    v_mul_f32 v6, v6, v5
    v_mul_f32 v7, v7, v5
    v_mul_f32 v8, v8, v5
    v_mul_f32 v9, v9, v5
    s_nop 0
    v_accvgpr_write_b32 a64, v6
    v_accvgpr_write_b32 a65, v7
    v_accvgpr_write_b32 a66, v8
    v_accvgpr_write_b32 a67, v9
    s_nop 0
    v_accvgpr_read_b32 v6, a68
    v_accvgpr_read_b32 v7, a69
    v_accvgpr_read_b32 v8, a70
    v_accvgpr_read_b32 v9, a71
    s_nop 0
    v_mul_f32 v6, v6, v5
    v_mul_f32 v7, v7, v5
    v_mul_f32 v8, v8, v5
    v_mul_f32 v9, v9, v5
    s_nop 0
    v_accvgpr_write_b32 a68, v6
    v_accvgpr_write_b32 a69, v7
    v_accvgpr_write_b32 a70, v8
    v_accvgpr_write_b32 a71, v9
    s_nop 0
    v_accvgpr_read_b32 v6, a72
    v_accvgpr_read_b32 v7, a73
    v_accvgpr_read_b32 v8, a74
    v_accvgpr_read_b32 v9, a75
    s_nop 0
    v_mul_f32 v6, v6, v5
    v_mul_f32 v7, v7, v5
    v_mul_f32 v8, v8, v5
    v_mul_f32 v9, v9, v5
    s_nop 0
    v_accvgpr_write_b32 a72, v6
    v_accvgpr_write_b32 a73, v7
    v_accvgpr_write_b32 a74, v8
    v_accvgpr_write_b32 a75, v9
    s_nop 0
    v_accvgpr_read_b32 v6, a76
    v_accvgpr_read_b32 v7, a77
    v_accvgpr_read_b32 v8, a78
    v_accvgpr_read_b32 v9, a79
    s_nop 0
    v_mul_f32 v6, v6, v5
    v_mul_f32 v7, v7, v5
    v_mul_f32 v8, v8, v5
    v_mul_f32 v9, v9, v5
    s_nop 0
    v_accvgpr_write_b32 a76, v6
    v_accvgpr_write_b32 a77, v7
    v_accvgpr_write_b32 a78, v8
    v_accvgpr_write_b32 a79, v9
    s_nop 0
    v_accvgpr_read_b32 v6, a80
    v_accvgpr_read_b32 v7, a81
    v_accvgpr_read_b32 v8, a82
    v_accvgpr_read_b32 v9, a83
    s_nop 0
    v_mul_f32 v6, v6, v5
    v_mul_f32 v7, v7, v5
    v_mul_f32 v8, v8, v5
    v_mul_f32 v9, v9, v5
    s_nop 0
    v_accvgpr_write_b32 a80, v6
    v_accvgpr_write_b32 a81, v7
    v_accvgpr_write_b32 a82, v8
    v_accvgpr_write_b32 a83, v9
    s_nop 0
    v_accvgpr_read_b32 v6, a84
    v_accvgpr_read_b32 v7, a85
    v_accvgpr_read_b32 v8, a86
    v_accvgpr_read_b32 v9, a87
    s_nop 0
    v_mul_f32 v6, v6, v5
    v_mul_f32 v7, v7, v5
    v_mul_f32 v8, v8, v5
    v_mul_f32 v9, v9, v5
    s_nop 0
    v_accvgpr_write_b32 a84, v6
    v_accvgpr_write_b32 a85, v7
    v_accvgpr_write_b32 a86, v8
    v_accvgpr_write_b32 a87, v9
    s_nop 0
    v_accvgpr_read_b32 v6, a88
    v_accvgpr_read_b32 v7, a89
    v_accvgpr_read_b32 v8, a90
    v_accvgpr_read_b32 v9, a91
    s_nop 0
    v_mul_f32 v6, v6, v5
    v_mul_f32 v7, v7, v5
    v_mul_f32 v8, v8, v5
    v_mul_f32 v9, v9, v5
    s_nop 0
    v_accvgpr_write_b32 a88, v6
    v_accvgpr_write_b32 a89, v7
    v_accvgpr_write_b32 a90, v8
    v_accvgpr_write_b32 a91, v9
    s_nop 0
    v_accvgpr_read_b32 v6, a92
    v_accvgpr_read_b32 v7, a93
    v_accvgpr_read_b32 v8, a94
    v_accvgpr_read_b32 v9, a95
    s_nop 0
    v_mul_f32 v6, v6, v5
    v_mul_f32 v7, v7, v5
    v_mul_f32 v8, v8, v5
    v_mul_f32 v9, v9, v5
    s_nop 0
    v_accvgpr_write_b32 a92, v6
    v_accvgpr_write_b32 a93, v7
    v_accvgpr_write_b32 a94, v8
    v_accvgpr_write_b32 a95, v9
    s_nop 0
    v_mul_f32 v76, v76, v5
    v_mul_f32 v77, v77, v5
    v_mul_f32 v78, v78, v5
    v_mul_f32 v79, v79, v5
    s_nop 1
    s_branch RET_1_2
SLOW_1_3:
    v_mov_b32 v3, v1
    s_nop 1
    v_permlane16_swap_b32 v1, v3
    s_nop 0
    v_max_f32 v1, v1, v3
    v_mov_b32 v3, v1
    s_nop 1
    v_permlane32_swap_b32 v1, v3
    s_nop 0
    v_max_f32 v1, v1, v3
    v_max_f32 v4, v28, v1
    v_sub_f32 v5, v28, v4
    v_mul_f32 v5, s36, v5
    v_exp_f32 v5, v5
    v_mov_b32 v28, v4
    v_add_f32 v33, 0x427af232, v4
    v_mul_f32 v38, 0xbe0293ee, v4
    s_cmp_lg_u32 s37, 0
    s_cbranch_scc1 RET_1_3
    s_nop 7
    v_accvgpr_read_b32 v6, a96
    v_accvgpr_read_b32 v7, a97
    v_accvgpr_read_b32 v8, a98
    v_accvgpr_read_b32 v9, a99
    s_nop 0
    v_mul_f32 v6, v6, v5
    v_mul_f32 v7, v7, v5
    v_mul_f32 v8, v8, v5
    v_mul_f32 v9, v9, v5
    s_nop 0
    v_accvgpr_write_b32 a96, v6
    v_accvgpr_write_b32 a97, v7
    v_accvgpr_write_b32 a98, v8
    v_accvgpr_write_b32 a99, v9
    s_nop 0
    v_accvgpr_read_b32 v6, a100
    v_accvgpr_read_b32 v7, a101
    v_accvgpr_read_b32 v8, a102
    v_accvgpr_read_b32 v9, a103
    s_nop 0
    v_mul_f32 v6, v6, v5
    v_mul_f32 v7, v7, v5
    v_mul_f32 v8, v8, v5
    v_mul_f32 v9, v9, v5
    s_nop 0
    v_accvgpr_write_b32 a100, v6
    v_accvgpr_write_b32 a101, v7
    v_accvgpr_write_b32 a102, v8
    v_accvgpr_write_b32 a103, v9
    s_nop 0
    v_accvgpr_read_b32 v6, a104
    v_accvgpr_read_b32 v7, a105
    v_accvgpr_read_b32 v8, a106
    v_accvgpr_read_b32 v9, a107
    s_nop 0
    v_mul_f32 v6, v6, v5
    v_mul_f32 v7, v7, v5
    v_mul_f32 v8, v8, v5
    v_mul_f32 v9, v9, v5
    s_nop 0
    v_accvgpr_write_b32 a104, v6
    v_accvgpr_write_b32 a105, v7
    v_accvgpr_write_b32 a106, v8
    v_accvgpr_write_b32 a107, v9
    s_nop 0
    v_accvgpr_read_b32 v6, a108
    v_accvgpr_read_b32 v7, a109
    v_accvgpr_read_b32 v8, a110
    v_accvgpr_read_b32 v9, a111
    s_nop 0
    v_mul_f32 v6, v6, v5
    v_mul_f32 v7, v7, v5
    v_mul_f32 v8, v8, v5
    v_mul_f32 v9, v9, v5
    s_nop 0
    v_accvgpr_write_b32 a108, v6
    v_accvgpr_write_b32 a109, v7
    v_accvgpr_write_b32 a110, v8
    v_accvgpr_write_b32 a111, v9
    s_nop 0
    v_accvgpr_read_b32 v6, a112
    v_accvgpr_read_b32 v7, a113
    v_accvgpr_read_b32 v8, a114
    v_accvgpr_read_b32 v9, a115
    s_nop 0
    v_mul_f32 v6, v6, v5
    v_mul_f32 v7, v7, v5
    v_mul_f32 v8, v8, v5
    v_mul_f32 v9, v9, v5
    s_nop 0
    v_accvgpr_write_b32 a112, v6
    v_accvgpr_write_b32 a113, v7
    v_accvgpr_write_b32 a114, v8
    v_accvgpr_write_b32 a115, v9
    s_nop 0
    v_accvgpr_read_b32 v6, a116
    v_accvgpr_read_b32 v7, a117
    v_accvgpr_read_b32 v8, a118
    v_accvgpr_read_b32 v9, a119
    s_nop 0
    v_mul_f32 v6, v6, v5
    v_mul_f32 v7, v7, v5
    v_mul_f32 v8, v8, v5
    v_mul_f32 v9, v9, v5
    s_nop 0
    v_accvgpr_write_b32 a116, v6
    v_accvgpr_write_b32 a117, v7
    v_accvgpr_write_b32 a118, v8
    v_accvgpr_write_b32 a119, v9
    s_nop 0
    v_accvgpr_read_b32 v6, a120
    v_accvgpr_read_b32 v7, a121
    v_accvgpr_read_b32 v8, a122
    v_accvgpr_read_b32 v9, a123
    s_nop 0
    v_mul_f32 v6, v6, v5
    v_mul_f32 v7, v7, v5
    v_mul_f32 v8, v8, v5
    v_mul_f32 v9, v9, v5
    s_nop 0
    v_accvgpr_write_b32 a120, v6
    v_accvgpr_write_b32 a121, v7
    v_accvgpr_write_b32 a122, v8
    v_accvgpr_write_b32 a123, v9
    s_nop 0
    v_accvgpr_read_b32 v6, a124
    v_accvgpr_read_b32 v7, a125
    v_accvgpr_read_b32 v8, a126
    v_accvgpr_read_b32 v9, a127
    s_nop 0
    v_mul_f32 v6, v6, v5
    v_mul_f32 v7, v7, v5
    v_mul_f32 v8, v8, v5
    v_mul_f32 v9, v9, v5
    s_nop 0
    v_accvgpr_write_b32 a124, v6
    v_accvgpr_write_b32 a125, v7
    v_accvgpr_write_b32 a126, v8
    v_accvgpr_write_b32 a127, v9
    s_nop 0
    v_mul_f32 v80, v80, v5
    v_mul_f32 v81, v81, v5
    v_mul_f32 v82, v82, v5
    v_mul_f32 v83, v83, v5
    s_nop 1
    s_branch RET_1_3
SLOW_1_4:
    v_mov_b32 v3, v1
    s_nop 1
    v_permlane16_swap_b32 v1, v3
    s_nop 0
    v_max_f32 v1, v1, v3
    v_mov_b32 v3, v1
    s_nop 1
    v_permlane32_swap_b32 v1, v3
    s_nop 0
    v_max_f32 v1, v1, v3
    v_max_f32 v4, v29, v1
    v_sub_f32 v5, v29, v4
    v_mul_f32 v5, s36, v5
    v_exp_f32 v5, v5
    v_mov_b32 v29, v4
    v_add_f32 v34, 0x427af232, v4
    v_mul_f32 v39, 0xbe0293ee, v4
    s_cmp_lg_u32 s37, 0
    s_cbranch_scc1 RET_1_4
    s_nop 7
    v_accvgpr_read_b32 v6, a128
    v_accvgpr_read_b32 v7, a129
    v_accvgpr_read_b32 v8, a130
    v_accvgpr_read_b32 v9, a131
    s_nop 0
    v_mul_f32 v6, v6, v5
    v_mul_f32 v7, v7, v5
    v_mul_f32 v8, v8, v5
    v_mul_f32 v9, v9, v5
    s_nop 0
    v_accvgpr_write_b32 a128, v6
    v_accvgpr_write_b32 a129, v7
    v_accvgpr_write_b32 a130, v8
    v_accvgpr_write_b32 a131, v9
    s_nop 0
    v_accvgpr_read_b32 v6, a132
    v_accvgpr_read_b32 v7, a133
    v_accvgpr_read_b32 v8, a134
    v_accvgpr_read_b32 v9, a135
    s_nop 0
    v_mul_f32 v6, v6, v5
    v_mul_f32 v7, v7, v5
    v_mul_f32 v8, v8, v5
    v_mul_f32 v9, v9, v5
    s_nop 0
    v_accvgpr_write_b32 a132, v6
    v_accvgpr_write_b32 a133, v7
    v_accvgpr_write_b32 a134, v8
    v_accvgpr_write_b32 a135, v9
    s_nop 0
    v_accvgpr_read_b32 v6, a136
    v_accvgpr_read_b32 v7, a137
    v_accvgpr_read_b32 v8, a138
    v_accvgpr_read_b32 v9, a139
    s_nop 0
    v_mul_f32 v6, v6, v5
    v_mul_f32 v7, v7, v5
    v_mul_f32 v8, v8, v5
    v_mul_f32 v9, v9, v5
    s_nop 0
    v_accvgpr_write_b32 a136, v6
    v_accvgpr_write_b32 a137, v7
    v_accvgpr_write_b32 a138, v8
    v_accvgpr_write_b32 a139, v9
    s_nop 0
    v_accvgpr_read_b32 v6, a140
    v_accvgpr_read_b32 v7, a141
    v_accvgpr_read_b32 v8, a142
    v_accvgpr_read_b32 v9, a143
    s_nop 0
    v_mul_f32 v6, v6, v5
    v_mul_f32 v7, v7, v5
    v_mul_f32 v8, v8, v5
    v_mul_f32 v9, v9, v5
    s_nop 0
    v_accvgpr_write_b32 a140, v6
    v_accvgpr_write_b32 a141, v7
    v_accvgpr_write_b32 a142, v8
    v_accvgpr_write_b32 a143, v9
    s_nop 0
    v_accvgpr_read_b32 v6, a144
    v_accvgpr_read_b32 v7, a145
    v_accvgpr_read_b32 v8, a146
    v_accvgpr_read_b32 v9, a147
    s_nop 0
    v_mul_f32 v6, v6, v5
    v_mul_f32 v7, v7, v5
    v_mul_f32 v8, v8, v5
    v_mul_f32 v9, v9, v5
    s_nop 0
    v_accvgpr_write_b32 a144, v6
    v_accvgpr_write_b32 a145, v7
    v_accvgpr_write_b32 a146, v8
    v_accvgpr_write_b32 a147, v9
    s_nop 0
    v_accvgpr_read_b32 v6, a148
    v_accvgpr_read_b32 v7, a149
    v_accvgpr_read_b32 v8, a150
    v_accvgpr_read_b32 v9, a151
    s_nop 0
    v_mul_f32 v6, v6, v5
    v_mul_f32 v7, v7, v5
    v_mul_f32 v8, v8, v5
    v_mul_f32 v9, v9, v5
    s_nop 0
    v_accvgpr_write_b32 a148, v6
    v_accvgpr_write_b32 a149, v7
    v_accvgpr_write_b32 a150, v8
    v_accvgpr_write_b32 a151, v9
    s_nop 0
    v_accvgpr_read_b32 v6, a152
    v_accvgpr_read_b32 v7, a153
    v_accvgpr_read_b32 v8, a154
    v_accvgpr_read_b32 v9, a155
    s_nop 0
    v_mul_f32 v6, v6, v5
    v_mul_f32 v7, v7, v5
    v_mul_f32 v8, v8, v5
    v_mul_f32 v9, v9, v5
    s_nop 0
    v_accvgpr_write_b32 a152, v6
    v_accvgpr_write_b32 a153, v7
    v_accvgpr_write_b32 a154, v8
    v_accvgpr_write_b32 a155, v9
    s_nop 0
    v_accvgpr_read_b32 v6, a156
    v_accvgpr_read_b32 v7, a157
    v_accvgpr_read_b32 v8, a158
    v_accvgpr_read_b32 v9, a159
    s_nop 0
    v_mul_f32 v6, v6, v5
    v_mul_f32 v7, v7, v5
    v_mul_f32 v8, v8, v5
    v_mul_f32 v9, v9, v5
    s_nop 0
    v_accvgpr_write_b32 a156, v6
    v_accvgpr_write_b32 a157, v7
    v_accvgpr_write_b32 a158, v8
    v_accvgpr_write_b32 a159, v9
    s_nop 0
    v_mul_f32 v84, v84, v5
    v_mul_f32 v85, v85, v5
    v_mul_f32 v86, v86, v5
    v_mul_f32 v87, v87, v5
    s_nop 1
    s_branch RET_1_4
SLOW_6_0:
    v_mov_b32 v3, v1
    s_nop 1
    v_permlane16_swap_b32 v1, v3
    s_nop 0
    v_max_f32 v1, v1, v3
    v_mov_b32 v3, v1
    s_nop 1
    v_permlane32_swap_b32 v1, v3
    s_nop 0
    v_max_f32 v1, v1, v3
    v_max_f32 v4, v25, v1
    v_sub_f32 v5, v25, v4
    v_mul_f32 v5, s36, v5
    v_exp_f32 v5, v5
    v_mov_b32 v25, v4
    v_add_f32 v30, 0x427af232, v4
    v_mul_f32 v35, 0xbe0293ee, v4
    s_cmp_lg_u32 s37, 0
    s_cbranch_scc1 RET_6_0
    s_nop 7
    v_accvgpr_read_b32 v6, a0
    v_accvgpr_read_b32 v7, a1
    v_accvgpr_read_b32 v8, a2
    v_accvgpr_read_b32 v9, a3
    s_nop 0
    v_mul_f32 v6, v6, v5
    v_mul_f32 v7, v7, v5
    v_mul_f32 v8, v8, v5
    v_mul_f32 v9, v9, v5
    s_nop 0
    v_accvgpr_write_b32 a0, v6
    v_accvgpr_write_b32 a1, v7
    v_accvgpr_write_b32 a2, v8
    v_accvgpr_write_b32 a3, v9
    s_nop 0
    v_accvgpr_read_b32 v6, a4
    v_accvgpr_read_b32 v7, a5
    v_accvgpr_read_b32 v8, a6
    v_accvgpr_read_b32 v9, a7
    s_nop 0
    v_mul_f32 v6, v6, v5
    v_mul_f32 v7, v7, v5
    v_mul_f32 v8, v8, v5
    v_mul_f32 v9, v9, v5
    s_nop 0
    v_accvgpr_write_b32 a4, v6
    v_accvgpr_write_b32 a5, v7
    v_accvgpr_write_b32 a6, v8
    v_accvgpr_write_b32 a7, v9
    s_nop 0
    v_accvgpr_read_b32 v6, a8
    v_accvgpr_read_b32 v7, a9
    v_accvgpr_read_b32 v8, a10
    v_accvgpr_read_b32 v9, a11
    s_nop 0
    v_mul_f32 v6, v6, v5
    v_mul_f32 v7, v7, v5
    v_mul_f32 v8, v8, v5
    v_mul_f32 v9, v9, v5
    s_nop 0
    v_accvgpr_write_b32 a8, v6
    v_accvgpr_write_b32 a9, v7
    v_accvgpr_write_b32 a10, v8
    v_accvgpr_write_b32 a11, v9
    s_nop 0
    v_accvgpr_read_b32 v6, a12
    v_accvgpr_read_b32 v7, a13
    v_accvgpr_read_b32 v8, a14
    v_accvgpr_read_b32 v9, a15
    s_nop 0
    v_mul_f32 v6, v6, v5
    v_mul_f32 v7, v7, v5
    v_mul_f32 v8, v8, v5
    v_mul_f32 v9, v9, v5
    s_nop 0
    v_accvgpr_write_b32 a12, v6
    v_accvgpr_write_b32 a13, v7
    v_accvgpr_write_b32 a14, v8
    v_accvgpr_write_b32 a15, v9
    s_nop 0
    v_accvgpr_read_b32 v6, a16
    v_accvgpr_read_b32 v7, a17
    v_accvgpr_read_b32 v8, a18
    v_accvgpr_read_b32 v9, a19
    s_nop 0
    v_mul_f32 v6, v6, v5
    v_mul_f32 v7, v7, v5
    v_mul_f32 v8, v8, v5
    v_mul_f32 v9, v9, v5
    s_nop 0
    v_accvgpr_write_b32 a16, v6
    v_accvgpr_write_b32 a17, v7
    v_accvgpr_write_b32 a18, v8
    v_accvgpr_write_b32 a19, v9
    s_nop 0
    v_accvgpr_read_b32 v6, a20
    v_accvgpr_read_b32 v7, a21
    v_accvgpr_read_b32 v8, a22
    v_accvgpr_read_b32 v9, a23
    s_nop 0
    v_mul_f32 v6, v6, v5
    v_mul_f32 v7, v7, v5
    v_mul_f32 v8, v8, v5
    v_mul_f32 v9, v9, v5
    s_nop 0
    v_accvgpr_write_b32 a20, v6
    v_accvgpr_write_b32 a21, v7
    v_accvgpr_write_b32 a22, v8
    v_accvgpr_write_b32 a23, v9
    s_nop 0
    v_accvgpr_read_b32 v6, a24
    v_accvgpr_read_b32 v7, a25
    v_accvgpr_read_b32 v8, a26
    v_accvgpr_read_b32 v9, a27
    s_nop 0
    v_mul_f32 v6, v6, v5
    v_mul_f32 v7, v7, v5
    v_mul_f32 v8, v8, v5
    v_mul_f32 v9, v9, v5
    s_nop 0
    v_accvgpr_write_b32 a24, v6
    v_accvgpr_write_b32 a25, v7
    v_accvgpr_write_b32 a26, v8
    v_accvgpr_write_b32 a27, v9
    s_nop 0
    v_accvgpr_read_b32 v6, a28
    v_accvgpr_read_b32 v7, a29
    v_accvgpr_read_b32 v8, a30
    v_accvgpr_read_b32 v9, a31
    s_nop 0
    v_mul_f32 v6, v6, v5
    v_mul_f32 v7, v7, v5
    v_mul_f32 v8, v8, v5
    v_mul_f32 v9, v9, v5
    s_nop 0
    v_accvgpr_write_b32 a28, v6
    v_accvgpr_write_b32 a29, v7
    v_accvgpr_write_b32 a30, v8
    v_accvgpr_write_b32 a31, v9
    s_nop 0
    v_mul_f32 v68, v68, v5
    v_mul_f32 v69, v69, v5
    v_mul_f32 v70, v70, v5
    v_mul_f32 v71, v71, v5
    s_nop 1
    s_branch RET_6_0
SLOW_6_1:
    v_mov_b32 v3, v1
    s_nop 1
    v_permlane16_swap_b32 v1, v3
    s_nop 0
    v_max_f32 v1, v1, v3
    v_mov_b32 v3, v1
    s_nop 1
    v_permlane32_swap_b32 v1, v3
    s_nop 0
    v_max_f32 v1, v1, v3
    v_max_f32 v4, v26, v1
    v_sub_f32 v5, v26, v4
    v_mul_f32 v5, s36, v5
    v_exp_f32 v5, v5
    v_mov_b32 v26, v4
    v_add_f32 v31, 0x427af232, v4
    v_mul_f32 v36, 0xbe0293ee, v4
    s_cmp_lg_u32 s37, 0
    s_cbranch_scc1 RET_6_1
    s_nop 7
    v_accvgpr_read_b32 v6, a32
    v_accvgpr_read_b32 v7, a33
    v_accvgpr_read_b32 v8, a34
    v_accvgpr_read_b32 v9, a35
    s_nop 0
    v_mul_f32 v6, v6, v5
    v_mul_f32 v7, v7, v5
    v_mul_f32 v8, v8, v5
    v_mul_f32 v9, v9, v5
    s_nop 0
    v_accvgpr_write_b32 a32, v6
    v_accvgpr_write_b32 a33, v7
    v_accvgpr_write_b32 a34, v8
    v_accvgpr_write_b32 a35, v9
    s_nop 0
    v_accvgpr_read_b32 v6, a36
    v_accvgpr_read_b32 v7, a37
    v_accvgpr_read_b32 v8, a38
    v_accvgpr_read_b32 v9, a39
    s_nop 0
    v_mul_f32 v6, v6, v5
    v_mul_f32 v7, v7, v5
    v_mul_f32 v8, v8, v5
    v_mul_f32 v9, v9, v5
    s_nop 0
    v_accvgpr_write_b32 a36, v6
    v_accvgpr_write_b32 a37, v7
    v_accvgpr_write_b32 a38, v8
    v_accvgpr_write_b32 a39, v9
    s_nop 0
    v_accvgpr_read_b32 v6, a40
    v_accvgpr_read_b32 v7, a41
    v_accvgpr_read_b32 v8, a42
    v_accvgpr_read_b32 v9, a43
    s_nop 0
    v_mul_f32 v6, v6, v5
    v_mul_f32 v7, v7, v5
    v_mul_f32 v8, v8, v5
    v_mul_f32 v9, v9, v5
    s_nop 0
    v_accvgpr_write_b32 a40, v6
    v_accvgpr_write_b32 a41, v7
    v_accvgpr_write_b32 a42, v8
    v_accvgpr_write_b32 a43, v9
    s_nop 0
    v_accvgpr_read_b32 v6, a44
    v_accvgpr_read_b32 v7, a45
    v_accvgpr_read_b32 v8, a46
    v_accvgpr_read_b32 v9, a47
    s_nop 0
    v_mul_f32 v6, v6, v5
    v_mul_f32 v7, v7, v5
    v_mul_f32 v8, v8, v5
    v_mul_f32 v9, v9, v5
    s_nop 0
    v_accvgpr_write_b32 a44, v6
    v_accvgpr_write_b32 a45, v7
    v_accvgpr_write_b32 a46, v8
    v_accvgpr_write_b32 a47, v9
    s_nop 0
    v_accvgpr_read_b32 v6, a48
    v_accvgpr_read_b32 v7, a49
    v_accvgpr_read_b32 v8, a50
    v_accvgpr_read_b32 v9, a51
    s_nop 0
    v_mul_f32 v6, v6, v5
    v_mul_f32 v7, v7, v5
    v_mul_f32 v8, v8, v5
    v_mul_f32 v9, v9, v5
    s_nop 0
    v_accvgpr_write_b32 a48, v6
    v_accvgpr_write_b32 a49, v7
    v_accvgpr_write_b32 a50, v8
    v_accvgpr_write_b32 a51, v9
    s_nop 0
    v_accvgpr_read_b32 v6, a52
    v_accvgpr_read_b32 v7, a53
    v_accvgpr_read_b32 v8, a54
    v_accvgpr_read_b32 v9, a55
    s_nop 0
    v_mul_f32 v6, v6, v5
    v_mul_f32 v7, v7, v5
    v_mul_f32 v8, v8, v5
    v_mul_f32 v9, v9, v5
    s_nop 0
    v_accvgpr_write_b32 a52, v6
    v_accvgpr_write_b32 a53, v7
    v_accvgpr_write_b32 a54, v8
    v_accvgpr_write_b32 a55, v9
    s_nop 0
    v_accvgpr_read_b32 v6, a56
    v_accvgpr_read_b32 v7, a57
    v_accvgpr_read_b32 v8, a58
    v_accvgpr_read_b32 v9, a59
    s_nop 0
    v_mul_f32 v6, v6, v5
    v_mul_f32 v7, v7, v5
    v_mul_f32 v8, v8, v5
    v_mul_f32 v9, v9, v5
    s_nop 0
    v_accvgpr_write_b32 a56, v6
    v_accvgpr_write_b32 a57, v7
    v_accvgpr_write_b32 a58, v8
    v_accvgpr_write_b32 a59, v9
    s_nop 0
    v_accvgpr_read_b32 v6, a60
    v_accvgpr_read_b32 v7, a61
    v_accvgpr_read_b32 v8, a62
    v_accvgpr_read_b32 v9, a63
    s_nop 0
    v_mul_f32 v6, v6, v5
    v_mul_f32 v7, v7, v5
    v_mul_f32 v8, v8, v5
    v_mul_f32 v9, v9, v5
    s_nop 0
    v_accvgpr_write_b32 a60, v6
    v_accvgpr_write_b32 a61, v7
    v_accvgpr_write_b32 a62, v8
    v_accvgpr_write_b32 a63, v9
    s_nop 0
    v_mul_f32 v72, v72, v5
    v_mul_f32 v73, v73, v5
    v_mul_f32 v74, v74, v5
    v_mul_f32 v75, v75, v5
    s_nop 1
    s_branch RET_6_1
SLOW_6_2:
    v_mov_b32 v3, v1
    s_nop 1
    v_permlane16_swap_b32 v1, v3
    s_nop 0
    v_max_f32 v1, v1, v3
    v_mov_b32 v3, v1
    s_nop 1
    v_permlane32_swap_b32 v1, v3
    s_nop 0
    v_max_f32 v1, v1, v3
    v_max_f32 v4, v27, v1
    v_sub_f32 v5, v27, v4
    v_mul_f32 v5, s36, v5
    v_exp_f32 v5, v5
    v_mov_b32 v27, v4
    v_add_f32 v32, 0x427af232, v4
    v_mul_f32 v37, 0xbe0293ee, v4
    s_cmp_lg_u32 s37, 0
    s_cbranch_scc1 RET_6_2
    s_nop 7
    v_accvgpr_read_b32 v6, a64
    v_accvgpr_read_b32 v7, a65
    v_accvgpr_read_b32 v8, a66
    v_accvgpr_read_b32 v9, a67
    s_nop 0
    v_mul_f32 v6, v6, v5
    v_mul_f32 v7, v7, v5
    v_mul_f32 v8, v8, v5
    v_mul_f32 v9, v9, v5
    s_nop 0
    v_accvgpr_write_b32 a64, v6
    v_accvgpr_write_b32 a65, v7
    v_accvgpr_write_b32 a66, v8
    v_accvgpr_write_b32 a67, v9
    s_nop 0
    v_accvgpr_read_b32 v6, a68
    v_accvgpr_read_b32 v7, a69
    v_accvgpr_read_b32 v8, a70
    v_accvgpr_read_b32 v9, a71
    s_nop 0
    v_mul_f32 v6, v6, v5
    v_mul_f32 v7, v7, v5
    v_mul_f32 v8, v8, v5
    v_mul_f32 v9, v9, v5
    s_nop 0
    v_accvgpr_write_b32 a68, v6
    v_accvgpr_write_b32 a69, v7
    v_accvgpr_write_b32 a70, v8
    v_accvgpr_write_b32 a71, v9
    s_nop 0
    v_accvgpr_read_b32 v6, a72
    v_accvgpr_read_b32 v7, a73
    v_accvgpr_read_b32 v8, a74
    v_accvgpr_read_b32 v9, a75
    s_nop 0
    v_mul_f32 v6, v6, v5
    v_mul_f32 v7, v7, v5
    v_mul_f32 v8, v8, v5
    v_mul_f32 v9, v9, v5
    s_nop 0
    v_accvgpr_write_b32 a72, v6
    v_accvgpr_write_b32 a73, v7
    v_accvgpr_write_b32 a74, v8
    v_accvgpr_write_b32 a75, v9
    s_nop 0
    v_accvgpr_read_b32 v6, a76
    v_accvgpr_read_b32 v7, a77
    v_accvgpr_read_b32 v8, a78
    v_accvgpr_read_b32 v9, a79
    s_nop 0
    v_mul_f32 v6, v6, v5
    v_mul_f32 v7, v7, v5
    v_mul_f32 v8, v8, v5
    v_mul_f32 v9, v9, v5
    s_nop 0
    v_accvgpr_write_b32 a76, v6
    v_accvgpr_write_b32 a77, v7
    v_accvgpr_write_b32 a78, v8
    v_accvgpr_write_b32 a79, v9
    s_nop 0
    v_accvgpr_read_b32 v6, a80
    v_accvgpr_read_b32 v7, a81
    v_accvgpr_read_b32 v8, a82
    v_accvgpr_read_b32 v9, a83
    s_nop 0
    v_mul_f32 v6, v6, v5
    v_mul_f32 v7, v7, v5
    v_mul_f32 v8, v8, v5
    v_mul_f32 v9, v9, v5
    s_nop 0
    v_accvgpr_write_b32 a80, v6
    v_accvgpr_write_b32 a81, v7
    v_accvgpr_write_b32 a82, v8
    v_accvgpr_write_b32 a83, v9
    s_nop 0
    v_accvgpr_read_b32 v6, a84
    v_accvgpr_read_b32 v7, a85
    v_accvgpr_read_b32 v8, a86
    v_accvgpr_read_b32 v9, a87
    s_nop 0
    v_mul_f32 v6, v6, v5
    v_mul_f32 v7, v7, v5
    v_mul_f32 v8, v8, v5
    v_mul_f32 v9, v9, v5
    s_nop 0
    v_accvgpr_write_b32 a84, v6
    v_accvgpr_write_b32 a85, v7
    v_accvgpr_write_b32 a86, v8
    v_accvgpr_write_b32 a87, v9
    s_nop 0
    v_accvgpr_read_b32 v6, a88
    v_accvgpr_read_b32 v7, a89
    v_accvgpr_read_b32 v8, a90
    v_accvgpr_read_b32 v9, a91
    s_nop 0
    v_mul_f32 v6, v6, v5
    v_mul_f32 v7, v7, v5
    v_mul_f32 v8, v8, v5
    v_mul_f32 v9, v9, v5
    s_nop 0
    v_accvgpr_write_b32 a88, v6
    v_accvgpr_write_b32 a89, v7
    v_accvgpr_write_b32 a90, v8
    v_accvgpr_write_b32 a91, v9
    s_nop 0
    v_accvgpr_read_b32 v6, a92
    v_accvgpr_read_b32 v7, a93
    v_accvgpr_read_b32 v8, a94
    v_accvgpr_read_b32 v9, a95
    s_nop 0
    v_mul_f32 v6, v6, v5
    v_mul_f32 v7, v7, v5
    v_mul_f32 v8, v8, v5
    v_mul_f32 v9, v9, v5
    s_nop 0
    v_accvgpr_write_b32 a92, v6
    v_accvgpr_write_b32 a93, v7
    v_accvgpr_write_b32 a94, v8
    v_accvgpr_write_b32 a95, v9
    s_nop 0
    v_mul_f32 v76, v76, v5
    v_mul_f32 v77, v77, v5
    v_mul_f32 v78, v78, v5
    v_mul_f32 v79, v79, v5
    s_nop 1
    s_branch RET_6_2
SLOW_6_3:
    v_mov_b32 v3, v1
    s_nop 1
    v_permlane16_swap_b32 v1, v3
    s_nop 0
    v_max_f32 v1, v1, v3
    v_mov_b32 v3, v1
    s_nop 1
    v_permlane32_swap_b32 v1, v3
    s_nop 0
    v_max_f32 v1, v1, v3
    v_max_f32 v4, v28, v1
    v_sub_f32 v5, v28, v4
    v_mul_f32 v5, s36, v5
    v_exp_f32 v5, v5
    v_mov_b32 v28, v4
    v_add_f32 v33, 0x427af232, v4
    v_mul_f32 v38, 0xbe0293ee, v4
    s_cmp_lg_u32 s37, 0
    s_cbranch_scc1 RET_6_3
    s_nop 7
    v_accvgpr_read_b32 v6, a96
    v_accvgpr_read_b32 v7, a97
    v_accvgpr_read_b32 v8, a98
    v_accvgpr_read_b32 v9, a99
    s_nop 0
    v_mul_f32 v6, v6, v5
    v_mul_f32 v7, v7, v5
    v_mul_f32 v8, v8, v5
    v_mul_f32 v9, v9, v5
    s_nop 0
    v_accvgpr_write_b32 a96, v6
    v_accvgpr_write_b32 a97, v7
    v_accvgpr_write_b32 a98, v8
    v_accvgpr_write_b32 a99, v9
    s_nop 0
    v_accvgpr_read_b32 v6, a100
    v_accvgpr_read_b32 v7, a101
    v_accvgpr_read_b32 v8, a102
    v_accvgpr_read_b32 v9, a103
    s_nop 0
    v_mul_f32 v6, v6, v5
    v_mul_f32 v7, v7, v5
    v_mul_f32 v8, v8, v5
    v_mul_f32 v9, v9, v5
    s_nop 0
    v_accvgpr_write_b32 a100, v6
    v_accvgpr_write_b32 a101, v7
    v_accvgpr_write_b32 a102, v8
    v_accvgpr_write_b32 a103, v9
    s_nop 0
    v_accvgpr_read_b32 v6, a104
    v_accvgpr_read_b32 v7, a105
    v_accvgpr_read_b32 v8, a106
    v_accvgpr_read_b32 v9, a107
    s_nop 0
    v_mul_f32 v6, v6, v5
    v_mul_f32 v7, v7, v5
    v_mul_f32 v8, v8, v5
    v_mul_f32 v9, v9, v5
    s_nop 0
    v_accvgpr_write_b32 a104, v6
    v_accvgpr_write_b32 a105, v7
    v_accvgpr_write_b32 a106, v8
    v_accvgpr_write_b32 a107, v9
    s_nop 0
    v_accvgpr_read_b32 v6, a108
    v_accvgpr_read_b32 v7, a109
    v_accvgpr_read_b32 v8, a110
    v_accvgpr_read_b32 v9, a111
    s_nop 0
    v_mul_f32 v6, v6, v5
    v_mul_f32 v7, v7, v5
    v_mul_f32 v8, v8, v5
    v_mul_f32 v9, v9, v5
    s_nop 0
    v_accvgpr_write_b32 a108, v6
    v_accvgpr_write_b32 a109, v7
    v_accvgpr_write_b32 a110, v8
    v_accvgpr_write_b32 a111, v9
    s_nop 0
    v_accvgpr_read_b32 v6, a112
    v_accvgpr_read_b32 v7, a113
    v_accvgpr_read_b32 v8, a114
    v_accvgpr_read_b32 v9, a115
    s_nop 0
    v_mul_f32 v6, v6, v5
    v_mul_f32 v7, v7, v5
    v_mul_f32 v8, v8, v5
    v_mul_f32 v9, v9, v5
    s_nop 0
    v_accvgpr_write_b32 a112, v6
    v_accvgpr_write_b32 a113, v7
    v_accvgpr_write_b32 a114, v8
    v_accvgpr_write_b32 a115, v9
    s_nop 0
    v_accvgpr_read_b32 v6, a116
    v_accvgpr_read_b32 v7, a117
    v_accvgpr_read_b32 v8, a118
    v_accvgpr_read_b32 v9, a119
    s_nop 0
    v_mul_f32 v6, v6, v5
    v_mul_f32 v7, v7, v5
    v_mul_f32 v8, v8, v5
    v_mul_f32 v9, v9, v5
    s_nop 0
    v_accvgpr_write_b32 a116, v6
    v_accvgpr_write_b32 a117, v7
    v_accvgpr_write_b32 a118, v8
    v_accvgpr_write_b32 a119, v9
    s_nop 0
    v_accvgpr_read_b32 v6, a120
    v_accvgpr_read_b32 v7, a121
    v_accvgpr_read_b32 v8, a122
    v_accvgpr_read_b32 v9, a123
    s_nop 0
    v_mul_f32 v6, v6, v5
    v_mul_f32 v7, v7, v5
    v_mul_f32 v8, v8, v5
    v_mul_f32 v9, v9, v5
    s_nop 0
    v_accvgpr_write_b32 a120, v6
    v_accvgpr_write_b32 a121, v7
    v_accvgpr_write_b32 a122, v8
    v_accvgpr_write_b32 a123, v9
    s_nop 0
    v_accvgpr_read_b32 v6, a124
    v_accvgpr_read_b32 v7, a125
    v_accvgpr_read_b32 v8, a126
    v_accvgpr_read_b32 v9, a127
    s_nop 0
    v_mul_f32 v6, v6, v5
    v_mul_f32 v7, v7, v5
    v_mul_f32 v8, v8, v5
    v_mul_f32 v9, v9, v5
    s_nop 0
    v_accvgpr_write_b32 a124, v6
    v_accvgpr_write_b32 a125, v7
    v_accvgpr_write_b32 a126, v8
    v_accvgpr_write_b32 a127, v9
    s_nop 0
    v_mul_f32 v80, v80, v5
    v_mul_f32 v81, v81, v5
    v_mul_f32 v82, v82, v5
    v_mul_f32 v83, v83, v5
    s_nop 1
    s_branch RET_6_3
SLOW_6_4:
    v_mov_b32 v3, v1
    s_nop 1
    v_permlane16_swap_b32 v1, v3
    s_nop 0
    v_max_f32 v1, v1, v3
    v_mov_b32 v3, v1
    s_nop 1
    v_permlane32_swap_b32 v1, v3
    s_nop 0
    v_max_f32 v1, v1, v3
    v_max_f32 v4, v29, v1
    v_sub_f32 v5, v29, v4
    v_mul_f32 v5, s36, v5
    v_exp_f32 v5, v5
    v_mov_b32 v29, v4
    v_add_f32 v34, 0x427af232, v4
    v_mul_f32 v39, 0xbe0293ee, v4
    s_cmp_lg_u32 s37, 0
    s_cbranch_scc1 RET_6_4
    s_nop 7
    v_accvgpr_read_b32 v6, a128
    v_accvgpr_read_b32 v7, a129
    v_accvgpr_read_b32 v8, a130
    v_accvgpr_read_b32 v9, a131
    s_nop 0
    v_mul_f32 v6, v6, v5
    v_mul_f32 v7, v7, v5
    v_mul_f32 v8, v8, v5
    v_mul_f32 v9, v9, v5
    s_nop 0
    v_accvgpr_write_b32 a128, v6
    v_accvgpr_write_b32 a129, v7
    v_accvgpr_write_b32 a130, v8
    v_accvgpr_write_b32 a131, v9
    s_nop 0
    v_accvgpr_read_b32 v6, a132
    v_accvgpr_read_b32 v7, a133
    v_accvgpr_read_b32 v8, a134
    v_accvgpr_read_b32 v9, a135
    s_nop 0
    v_mul_f32 v6, v6, v5
    v_mul_f32 v7, v7, v5
    v_mul_f32 v8, v8, v5
    v_mul_f32 v9, v9, v5
    s_nop 0
    v_accvgpr_write_b32 a132, v6
    v_accvgpr_write_b32 a133, v7
    v_accvgpr_write_b32 a134, v8
    v_accvgpr_write_b32 a135, v9
    s_nop 0
    v_accvgpr_read_b32 v6, a136
    v_accvgpr_read_b32 v7, a137
    v_accvgpr_read_b32 v8, a138
    v_accvgpr_read_b32 v9, a139
    s_nop 0
    v_mul_f32 v6, v6, v5
    v_mul_f32 v7, v7, v5
    v_mul_f32 v8, v8, v5
    v_mul_f32 v9, v9, v5
    s_nop 0
    v_accvgpr_write_b32 a136, v6
    v_accvgpr_write_b32 a137, v7
    v_accvgpr_write_b32 a138, v8
    v_accvgpr_write_b32 a139, v9
    s_nop 0
    v_accvgpr_read_b32 v6, a140
    v_accvgpr_read_b32 v7, a141
    v_accvgpr_read_b32 v8, a142
    v_accvgpr_read_b32 v9, a143
    s_nop 0
    v_mul_f32 v6, v6, v5
    v_mul_f32 v7, v7, v5
    v_mul_f32 v8, v8, v5
    v_mul_f32 v9, v9, v5
    s_nop 0
    v_accvgpr_write_b32 a140, v6
    v_accvgpr_write_b32 a141, v7
    v_accvgpr_write_b32 a142, v8
    v_accvgpr_write_b32 a143, v9
    s_nop 0
    v_accvgpr_read_b32 v6, a144
    v_accvgpr_read_b32 v7, a145
    v_accvgpr_read_b32 v8, a146
    v_accvgpr_read_b32 v9, a147
    s_nop 0
    v_mul_f32 v6, v6, v5
    v_mul_f32 v7, v7, v5
    v_mul_f32 v8, v8, v5
    v_mul_f32 v9, v9, v5
    s_nop 0
    v_accvgpr_write_b32 a144, v6
    v_accvgpr_write_b32 a145, v7
    v_accvgpr_write_b32 a146, v8
    v_accvgpr_write_b32 a147, v9
    s_nop 0
    v_accvgpr_read_b32 v6, a148
    v_accvgpr_read_b32 v7, a149
    v_accvgpr_read_b32 v8, a150
    v_accvgpr_read_b32 v9, a151
    s_nop 0
    v_mul_f32 v6, v6, v5
    v_mul_f32 v7, v7, v5
    v_mul_f32 v8, v8, v5
    v_mul_f32 v9, v9, v5
    s_nop 0
    v_accvgpr_write_b32 a148, v6
    v_accvgpr_write_b32 a149, v7
    v_accvgpr_write_b32 a150, v8
    v_accvgpr_write_b32 a151, v9
    s_nop 0
    v_accvgpr_read_b32 v6, a152
    v_accvgpr_read_b32 v7, a153
    v_accvgpr_read_b32 v8, a154
    v_accvgpr_read_b32 v9, a155
    s_nop 0
    v_mul_f32 v6, v6, v5
    v_mul_f32 v7, v7, v5
    v_mul_f32 v8, v8, v5
    v_mul_f32 v9, v9, v5
    s_nop 0
    v_accvgpr_write_b32 a152, v6
    v_accvgpr_write_b32 a153, v7
    v_accvgpr_write_b32 a154, v8
    v_accvgpr_write_b32 a155, v9
    s_nop 0
    v_accvgpr_read_b32 v6, a156
    v_accvgpr_read_b32 v7, a157
    v_accvgpr_read_b32 v8, a158
    v_accvgpr_read_b32 v9, a159
    s_nop 0
    v_mul_f32 v6, v6, v5
    v_mul_f32 v7, v7, v5
    v_mul_f32 v8, v8, v5
    v_mul_f32 v9, v9, v5
    s_nop 0
    v_accvgpr_write_b32 a156, v6
    v_accvgpr_write_b32 a157, v7
    v_accvgpr_write_b32 a158, v8
    v_accvgpr_write_b32 a159, v9
    s_nop 0
    v_mul_f32 v84, v84, v5
    v_mul_f32 v85, v85, v5
    v_mul_f32 v86, v86, v5
    v_mul_f32 v87, v87, v5
    s_nop 1
    s_branch RET_6_4
SLOW_7_0:
    v_mov_b32 v3, v1
    s_nop 1
    v_permlane16_swap_b32 v1, v3
    s_nop 0
    v_max_f32 v1, v1, v3
    v_mov_b32 v3, v1
    s_nop 1
    v_permlane32_swap_b32 v1, v3
    s_nop 0
    v_max_f32 v1, v1, v3
    v_max_f32 v4, v25, v1
    v_sub_f32 v5, v25, v4
    v_mul_f32 v5, s36, v5
    v_exp_f32 v5, v5
    v_mov_b32 v25, v4
    v_add_f32 v30, 0x427af232, v4
    v_mul_f32 v35, 0xbe0293ee, v4
    s_cmp_lg_u32 s37, 0
    s_cbranch_scc1 RET_7_0
    s_nop 7
    v_accvgpr_read_b32 v6, a0
    v_accvgpr_read_b32 v7, a1
    v_accvgpr_read_b32 v8, a2
    v_accvgpr_read_b32 v9, a3
    s_nop 0
    v_mul_f32 v6, v6, v5
    v_mul_f32 v7, v7, v5
    v_mul_f32 v8, v8, v5
    v_mul_f32 v9, v9, v5
    s_nop 0
    v_accvgpr_write_b32 a0, v6
    v_accvgpr_write_b32 a1, v7
    v_accvgpr_write_b32 a2, v8
    v_accvgpr_write_b32 a3, v9
    s_nop 0
    v_accvgpr_read_b32 v6, a4
    v_accvgpr_read_b32 v7, a5
    v_accvgpr_read_b32 v8, a6
    v_accvgpr_read_b32 v9, a7
    s_nop 0
    v_mul_f32 v6, v6, v5
    v_mul_f32 v7, v7, v5
    v_mul_f32 v8, v8, v5
    v_mul_f32 v9, v9, v5
    s_nop 0
    v_accvgpr_write_b32 a4, v6
    v_accvgpr_write_b32 a5, v7
    v_accvgpr_write_b32 a6, v8
    v_accvgpr_write_b32 a7, v9
    s_nop 0
    v_accvgpr_read_b32 v6, a8
    v_accvgpr_read_b32 v7, a9
    v_accvgpr_read_b32 v8, a10
    v_accvgpr_read_b32 v9, a11
    s_nop 0
    v_mul_f32 v6, v6, v5
    v_mul_f32 v7, v7, v5
    v_mul_f32 v8, v8, v5
    v_mul_f32 v9, v9, v5
    s_nop 0
    v_accvgpr_write_b32 a8, v6
    v_accvgpr_write_b32 a9, v7
    v_accvgpr_write_b32 a10, v8
    v_accvgpr_write_b32 a11, v9
    s_nop 0
    v_accvgpr_read_b32 v6, a12
    v_accvgpr_read_b32 v7, a13
    v_accvgpr_read_b32 v8, a14
    v_accvgpr_read_b32 v9, a15
    s_nop 0
    v_mul_f32 v6, v6, v5
    v_mul_f32 v7, v7, v5
    v_mul_f32 v8, v8, v5
    v_mul_f32 v9, v9, v5
    s_nop 0
    v_accvgpr_write_b32 a12, v6
    v_accvgpr_write_b32 a13, v7
    v_accvgpr_write_b32 a14, v8
    v_accvgpr_write_b32 a15, v9
    s_nop 0
    v_accvgpr_read_b32 v6, a16
    v_accvgpr_read_b32 v7, a17
    v_accvgpr_read_b32 v8, a18
    v_accvgpr_read_b32 v9, a19
    s_nop 0
    v_mul_f32 v6, v6, v5
    v_mul_f32 v7, v7, v5
    v_mul_f32 v8, v8, v5
    v_mul_f32 v9, v9, v5
    s_nop 0
    v_accvgpr_write_b32 a16, v6
    v_accvgpr_write_b32 a17, v7
    v_accvgpr_write_b32 a18, v8
    v_accvgpr_write_b32 a19, v9
    s_nop 0
    v_accvgpr_read_b32 v6, a20
    v_accvgpr_read_b32 v7, a21
    v_accvgpr_read_b32 v8, a22
    v_accvgpr_read_b32 v9, a23
    s_nop 0
    v_mul_f32 v6, v6, v5
    v_mul_f32 v7, v7, v5
    v_mul_f32 v8, v8, v5
    v_mul_f32 v9, v9, v5
    s_nop 0
    v_accvgpr_write_b32 a20, v6
    v_accvgpr_write_b32 a21, v7
    v_accvgpr_write_b32 a22, v8
    v_accvgpr_write_b32 a23, v9
    s_nop 0
    v_accvgpr_read_b32 v6, a24
    v_accvgpr_read_b32 v7, a25
    v_accvgpr_read_b32 v8, a26
    v_accvgpr_read_b32 v9, a27
    s_nop 0
    v_mul_f32 v6, v6, v5
    v_mul_f32 v7, v7, v5
    v_mul_f32 v8, v8, v5
    v_mul_f32 v9, v9, v5
    s_nop 0
    v_accvgpr_write_b32 a24, v6
    v_accvgpr_write_b32 a25, v7
    v_accvgpr_write_b32 a26, v8
    v_accvgpr_write_b32 a27, v9
    s_nop 0
    v_accvgpr_read_b32 v6, a28
    v_accvgpr_read_b32 v7, a29
    v_accvgpr_read_b32 v8, a30
    v_accvgpr_read_b32 v9, a31
    s_nop 0
    v_mul_f32 v6, v6, v5
    v_mul_f32 v7, v7, v5
    v_mul_f32 v8, v8, v5
    v_mul_f32 v9, v9, v5
    s_nop 0
    v_accvgpr_write_b32 a28, v6
    v_accvgpr_write_b32 a29, v7
    v_accvgpr_write_b32 a30, v8
    v_accvgpr_write_b32 a31, v9
    s_nop 0
    v_mul_f32 v68, v68, v5
    v_mul_f32 v69, v69, v5
    v_mul_f32 v70, v70, v5
    v_mul_f32 v71, v71, v5
    s_nop 1
    s_branch RET_7_0
SLOW_7_1:
    v_mov_b32 v3, v1
    s_nop 1
    v_permlane16_swap_b32 v1, v3
    s_nop 0
    v_max_f32 v1, v1, v3
    v_mov_b32 v3, v1
    s_nop 1
    v_permlane32_swap_b32 v1, v3
    s_nop 0
    v_max_f32 v1, v1, v3
    v_max_f32 v4, v26, v1
    v_sub_f32 v5, v26, v4
    v_mul_f32 v5, s36, v5
    v_exp_f32 v5, v5
    v_mov_b32 v26, v4
    v_add_f32 v31, 0x427af232, v4
    v_mul_f32 v36, 0xbe0293ee, v4
    s_cmp_lg_u32 s37, 0
    s_cbranch_scc1 RET_7_1
    s_nop 7
    v_accvgpr_read_b32 v6, a32
    v_accvgpr_read_b32 v7, a33
    v_accvgpr_read_b32 v8, a34
    v_accvgpr_read_b32 v9, a35
    s_nop 0
    v_mul_f32 v6, v6, v5
    v_mul_f32 v7, v7, v5
    v_mul_f32 v8, v8, v5
    v_mul_f32 v9, v9, v5
    s_nop 0
    v_accvgpr_write_b32 a32, v6
    v_accvgpr_write_b32 a33, v7
    v_accvgpr_write_b32 a34, v8
    v_accvgpr_write_b32 a35, v9
    s_nop 0
    v_accvgpr_read_b32 v6, a36
    v_accvgpr_read_b32 v7, a37
    v_accvgpr_read_b32 v8, a38
    v_accvgpr_read_b32 v9, a39
    s_nop 0
    v_mul_f32 v6, v6, v5
    v_mul_f32 v7, v7, v5
    v_mul_f32 v8, v8, v5
    v_mul_f32 v9, v9, v5
    s_nop 0
    v_accvgpr_write_b32 a36, v6
    v_accvgpr_write_b32 a37, v7
    v_accvgpr_write_b32 a38, v8
    v_accvgpr_write_b32 a39, v9
    s_nop 0
    v_accvgpr_read_b32 v6, a40
    v_accvgpr_read_b32 v7, a41
    v_accvgpr_read_b32 v8, a42
    v_accvgpr_read_b32 v9, a43
    s_nop 0
    v_mul_f32 v6, v6, v5
    v_mul_f32 v7, v7, v5
    v_mul_f32 v8, v8, v5
    v_mul_f32 v9, v9, v5
    s_nop 0
    v_accvgpr_write_b32 a40, v6
    v_accvgpr_write_b32 a41, v7
    v_accvgpr_write_b32 a42, v8
    v_accvgpr_write_b32 a43, v9
    s_nop 0
    v_accvgpr_read_b32 v6, a44
    v_accvgpr_read_b32 v7, a45
    v_accvgpr_read_b32 v8, a46
    v_accvgpr_read_b32 v9, a47
    s_nop 0
    v_mul_f32 v6, v6, v5
    v_mul_f32 v7, v7, v5
    v_mul_f32 v8, v8, v5
    v_mul_f32 v9, v9, v5
    s_nop 0
    v_accvgpr_write_b32 a44, v6
    v_accvgpr_write_b32 a45, v7
    v_accvgpr_write_b32 a46, v8
    v_accvgpr_write_b32 a47, v9
    s_nop 0
    v_accvgpr_read_b32 v6, a48
    v_accvgpr_read_b32 v7, a49
    v_accvgpr_read_b32 v8, a50
    v_accvgpr_read_b32 v9, a51
    s_nop 0
    v_mul_f32 v6, v6, v5
    v_mul_f32 v7, v7, v5
    v_mul_f32 v8, v8, v5
    v_mul_f32 v9, v9, v5
    s_nop 0
    v_accvgpr_write_b32 a48, v6
    v_accvgpr_write_b32 a49, v7
    v_accvgpr_write_b32 a50, v8
    v_accvgpr_write_b32 a51, v9
    s_nop 0
    v_accvgpr_read_b32 v6, a52
    v_accvgpr_read_b32 v7, a53
    v_accvgpr_read_b32 v8, a54
    v_accvgpr_read_b32 v9, a55
    s_nop 0
    v_mul_f32 v6, v6, v5
    v_mul_f32 v7, v7, v5
    v_mul_f32 v8, v8, v5
    v_mul_f32 v9, v9, v5
    s_nop 0
    v_accvgpr_write_b32 a52, v6
    v_accvgpr_write_b32 a53, v7
    v_accvgpr_write_b32 a54, v8
    v_accvgpr_write_b32 a55, v9
    s_nop 0
    v_accvgpr_read_b32 v6, a56
    v_accvgpr_read_b32 v7, a57
    v_accvgpr_read_b32 v8, a58
    v_accvgpr_read_b32 v9, a59
    s_nop 0
    v_mul_f32 v6, v6, v5
    v_mul_f32 v7, v7, v5
    v_mul_f32 v8, v8, v5
    v_mul_f32 v9, v9, v5
    s_nop 0
    v_accvgpr_write_b32 a56, v6
    v_accvgpr_write_b32 a57, v7
    v_accvgpr_write_b32 a58, v8
    v_accvgpr_write_b32 a59, v9
    s_nop 0
    v_accvgpr_read_b32 v6, a60
    v_accvgpr_read_b32 v7, a61
    v_accvgpr_read_b32 v8, a62
    v_accvgpr_read_b32 v9, a63
    s_nop 0
    v_mul_f32 v6, v6, v5
    v_mul_f32 v7, v7, v5
    v_mul_f32 v8, v8, v5
    v_mul_f32 v9, v9, v5
    s_nop 0
    v_accvgpr_write_b32 a60, v6
    v_accvgpr_write_b32 a61, v7
    v_accvgpr_write_b32 a62, v8
    v_accvgpr_write_b32 a63, v9
    s_nop 0
    v_mul_f32 v72, v72, v5
    v_mul_f32 v73, v73, v5
    v_mul_f32 v74, v74, v5
    v_mul_f32 v75, v75, v5
    s_nop 1
    s_branch RET_7_1
SLOW_7_2:
    v_mov_b32 v3, v1
    s_nop 1
    v_permlane16_swap_b32 v1, v3
    s_nop 0
    v_max_f32 v1, v1, v3
    v_mov_b32 v3, v1
    s_nop 1
    v_permlane32_swap_b32 v1, v3
    s_nop 0
    v_max_f32 v1, v1, v3
    v_max_f32 v4, v27, v1
    v_sub_f32 v5, v27, v4
    v_mul_f32 v5, s36, v5
    v_exp_f32 v5, v5
    v_mov_b32 v27, v4
    v_add_f32 v32, 0x427af232, v4
    v_mul_f32 v37, 0xbe0293ee, v4
    s_cmp_lg_u32 s37, 0
    s_cbranch_scc1 RET_7_2
    s_nop 7
    v_accvgpr_read_b32 v6, a64
    v_accvgpr_read_b32 v7, a65
    v_accvgpr_read_b32 v8, a66
    v_accvgpr_read_b32 v9, a67
    s_nop 0
    v_mul_f32 v6, v6, v5
    v_mul_f32 v7, v7, v5
    v_mul_f32 v8, v8, v5
    v_mul_f32 v9, v9, v5
    s_nop 0
    v_accvgpr_write_b32 a64, v6
    v_accvgpr_write_b32 a65, v7
    v_accvgpr_write_b32 a66, v8
    v_accvgpr_write_b32 a67, v9
    s_nop 0
    v_accvgpr_read_b32 v6, a68
    v_accvgpr_read_b32 v7, a69
    v_accvgpr_read_b32 v8, a70
    v_accvgpr_read_b32 v9, a71
    s_nop 0
    v_mul_f32 v6, v6, v5
    v_mul_f32 v7, v7, v5
    v_mul_f32 v8, v8, v5
    v_mul_f32 v9, v9, v5
    s_nop 0
    v_accvgpr_write_b32 a68, v6
    v_accvgpr_write_b32 a69, v7
    v_accvgpr_write_b32 a70, v8
    v_accvgpr_write_b32 a71, v9
    s_nop 0
    v_accvgpr_read_b32 v6, a72
    v_accvgpr_read_b32 v7, a73
    v_accvgpr_read_b32 v8, a74
    v_accvgpr_read_b32 v9, a75
    s_nop 0
    v_mul_f32 v6, v6, v5
    v_mul_f32 v7, v7, v5
    v_mul_f32 v8, v8, v5
    v_mul_f32 v9, v9, v5
    s_nop 0
    v_accvgpr_write_b32 a72, v6
    v_accvgpr_write_b32 a73, v7
    v_accvgpr_write_b32 a74, v8
    v_accvgpr_write_b32 a75, v9
    s_nop 0
    v_accvgpr_read_b32 v6, a76
    v_accvgpr_read_b32 v7, a77
    v_accvgpr_read_b32 v8, a78
    v_accvgpr_read_b32 v9, a79
    s_nop 0
    v_mul_f32 v6, v6, v5
    v_mul_f32 v7, v7, v5
    v_mul_f32 v8, v8, v5
    v_mul_f32 v9, v9, v5
    s_nop 0
    v_accvgpr_write_b32 a76, v6
    v_accvgpr_write_b32 a77, v7
    v_accvgpr_write_b32 a78, v8
    v_accvgpr_write_b32 a79, v9
    s_nop 0
    v_accvgpr_read_b32 v6, a80
    v_accvgpr_read_b32 v7, a81
    v_accvgpr_read_b32 v8, a82
    v_accvgpr_read_b32 v9, a83
    s_nop 0
    v_mul_f32 v6, v6, v5
    v_mul_f32 v7, v7, v5
    v_mul_f32 v8, v8, v5
    v_mul_f32 v9, v9, v5
    s_nop 0
    v_accvgpr_write_b32 a80, v6
    v_accvgpr_write_b32 a81, v7
    v_accvgpr_write_b32 a82, v8
    v_accvgpr_write_b32 a83, v9
    s_nop 0
    v_accvgpr_read_b32 v6, a84
    v_accvgpr_read_b32 v7, a85
    v_accvgpr_read_b32 v8, a86
    v_accvgpr_read_b32 v9, a87
    s_nop 0
    v_mul_f32 v6, v6, v5
    v_mul_f32 v7, v7, v5
    v_mul_f32 v8, v8, v5
    v_mul_f32 v9, v9, v5
    s_nop 0
    v_accvgpr_write_b32 a84, v6
    v_accvgpr_write_b32 a85, v7
    v_accvgpr_write_b32 a86, v8
    v_accvgpr_write_b32 a87, v9
    s_nop 0
    v_accvgpr_read_b32 v6, a88
    v_accvgpr_read_b32 v7, a89
    v_accvgpr_read_b32 v8, a90
    v_accvgpr_read_b32 v9, a91
    s_nop 0
    v_mul_f32 v6, v6, v5
    v_mul_f32 v7, v7, v5
    v_mul_f32 v8, v8, v5
    v_mul_f32 v9, v9, v5
    s_nop 0
    v_accvgpr_write_b32 a88, v6
    v_accvgpr_write_b32 a89, v7
    v_accvgpr_write_b32 a90, v8
    v_accvgpr_write_b32 a91, v9
    s_nop 0
    v_accvgpr_read_b32 v6, a92
    v_accvgpr_read_b32 v7, a93
    v_accvgpr_read_b32 v8, a94
    v_accvgpr_read_b32 v9, a95
    s_nop 0
    v_mul_f32 v6, v6, v5
    v_mul_f32 v7, v7, v5
    v_mul_f32 v8, v8, v5
    v_mul_f32 v9, v9, v5
    s_nop 0
    v_accvgpr_write_b32 a92, v6
    v_accvgpr_write_b32 a93, v7
    v_accvgpr_write_b32 a94, v8
    v_accvgpr_write_b32 a95, v9
    s_nop 0
    v_mul_f32 v76, v76, v5
    v_mul_f32 v77, v77, v5
    v_mul_f32 v78, v78, v5
    v_mul_f32 v79, v79, v5
    s_nop 1
    s_branch RET_7_2
SLOW_7_3:
    v_mov_b32 v3, v1
    s_nop 1
    v_permlane16_swap_b32 v1, v3
    s_nop 0
    v_max_f32 v1, v1, v3
    v_mov_b32 v3, v1
    s_nop 1
    v_permlane32_swap_b32 v1, v3
    s_nop 0
    v_max_f32 v1, v1, v3
    v_max_f32 v4, v28, v1
    v_sub_f32 v5, v28, v4
    v_mul_f32 v5, s36, v5
    v_exp_f32 v5, v5
    v_mov_b32 v28, v4
    v_add_f32 v33, 0x427af232, v4
    v_mul_f32 v38, 0xbe0293ee, v4
    s_cmp_lg_u32 s37, 0
    s_cbranch_scc1 RET_7_3
    s_nop 7
    v_accvgpr_read_b32 v6, a96
    v_accvgpr_read_b32 v7, a97
    v_accvgpr_read_b32 v8, a98
    v_accvgpr_read_b32 v9, a99
    s_nop 0
    v_mul_f32 v6, v6, v5
    v_mul_f32 v7, v7, v5
    v_mul_f32 v8, v8, v5
    v_mul_f32 v9, v9, v5
    s_nop 0
    v_accvgpr_write_b32 a96, v6
    v_accvgpr_write_b32 a97, v7
    v_accvgpr_write_b32 a98, v8
    v_accvgpr_write_b32 a99, v9
    s_nop 0
    v_accvgpr_read_b32 v6, a100
    v_accvgpr_read_b32 v7, a101
    v_accvgpr_read_b32 v8, a102
    v_accvgpr_read_b32 v9, a103
    s_nop 0
    v_mul_f32 v6, v6, v5
    v_mul_f32 v7, v7, v5
    v_mul_f32 v8, v8, v5
    v_mul_f32 v9, v9, v5
    s_nop 0
    v_accvgpr_write_b32 a100, v6
    v_accvgpr_write_b32 a101, v7
    v_accvgpr_write_b32 a102, v8
    v_accvgpr_write_b32 a103, v9
    s_nop 0
    v_accvgpr_read_b32 v6, a104
    v_accvgpr_read_b32 v7, a105
    v_accvgpr_read_b32 v8, a106
    v_accvgpr_read_b32 v9, a107
    s_nop 0
    v_mul_f32 v6, v6, v5
    v_mul_f32 v7, v7, v5
    v_mul_f32 v8, v8, v5
    v_mul_f32 v9, v9, v5
    s_nop 0
    v_accvgpr_write_b32 a104, v6
    v_accvgpr_write_b32 a105, v7
    v_accvgpr_write_b32 a106, v8
    v_accvgpr_write_b32 a107, v9
    s_nop 0
    v_accvgpr_read_b32 v6, a108
    v_accvgpr_read_b32 v7, a109
    v_accvgpr_read_b32 v8, a110
    v_accvgpr_read_b32 v9, a111
    s_nop 0
    v_mul_f32 v6, v6, v5
    v_mul_f32 v7, v7, v5
    v_mul_f32 v8, v8, v5
    v_mul_f32 v9, v9, v5
    s_nop 0
    v_accvgpr_write_b32 a108, v6
    v_accvgpr_write_b32 a109, v7
    v_accvgpr_write_b32 a110, v8
    v_accvgpr_write_b32 a111, v9
    s_nop 0
    v_accvgpr_read_b32 v6, a112
    v_accvgpr_read_b32 v7, a113
    v_accvgpr_read_b32 v8, a114
    v_accvgpr_read_b32 v9, a115
    s_nop 0
    v_mul_f32 v6, v6, v5
    v_mul_f32 v7, v7, v5
    v_mul_f32 v8, v8, v5
    v_mul_f32 v9, v9, v5
    s_nop 0
    v_accvgpr_write_b32 a112, v6
    v_accvgpr_write_b32 a113, v7
    v_accvgpr_write_b32 a114, v8
    v_accvgpr_write_b32 a115, v9
    s_nop 0
    v_accvgpr_read_b32 v6, a116
    v_accvgpr_read_b32 v7, a117
    v_accvgpr_read_b32 v8, a118
    v_accvgpr_read_b32 v9, a119
    s_nop 0
    v_mul_f32 v6, v6, v5
    v_mul_f32 v7, v7, v5
    v_mul_f32 v8, v8, v5
    v_mul_f32 v9, v9, v5
    s_nop 0
    v_accvgpr_write_b32 a116, v6
    v_accvgpr_write_b32 a117, v7
    v_accvgpr_write_b32 a118, v8
    v_accvgpr_write_b32 a119, v9
    s_nop 0
    v_accvgpr_read_b32 v6, a120
    v_accvgpr_read_b32 v7, a121
    v_accvgpr_read_b32 v8, a122
    v_accvgpr_read_b32 v9, a123
    s_nop 0
    v_mul_f32 v6, v6, v5
    v_mul_f32 v7, v7, v5
    v_mul_f32 v8, v8, v5
    v_mul_f32 v9, v9, v5
    s_nop 0
    v_accvgpr_write_b32 a120, v6
    v_accvgpr_write_b32 a121, v7
    v_accvgpr_write_b32 a122, v8
    v_accvgpr_write_b32 a123, v9
    s_nop 0
    v_accvgpr_read_b32 v6, a124
    v_accvgpr_read_b32 v7, a125
    v_accvgpr_read_b32 v8, a126
    v_accvgpr_read_b32 v9, a127
    s_nop 0
    v_mul_f32 v6, v6, v5
    v_mul_f32 v7, v7, v5
    v_mul_f32 v8, v8, v5
    v_mul_f32 v9, v9, v5
    s_nop 0
    v_accvgpr_write_b32 a124, v6
    v_accvgpr_write_b32 a125, v7
    v_accvgpr_write_b32 a126, v8
    v_accvgpr_write_b32 a127, v9
    s_nop 0
    v_mul_f32 v80, v80, v5
    v_mul_f32 v81, v81, v5
    v_mul_f32 v82, v82, v5
    v_mul_f32 v83, v83, v5
    s_nop 1
    s_branch RET_7_3
SLOW_7_4:
    v_mov_b32 v3, v1
    s_nop 1
    v_permlane16_swap_b32 v1, v3
    s_nop 0
    v_max_f32 v1, v1, v3
    v_mov_b32 v3, v1
    s_nop 1
    v_permlane32_swap_b32 v1, v3
    s_nop 0
    v_max_f32 v1, v1, v3
    v_max_f32 v4, v29, v1
    v_sub_f32 v5, v29, v4
    v_mul_f32 v5, s36, v5
    v_exp_f32 v5, v5
    v_mov_b32 v29, v4
    v_add_f32 v34, 0x427af232, v4
    v_mul_f32 v39, 0xbe0293ee, v4
    s_cmp_lg_u32 s37, 0
    s_cbranch_scc1 RET_7_4
    s_nop 7
    v_accvgpr_read_b32 v6, a128
    v_accvgpr_read_b32 v7, a129
    v_accvgpr_read_b32 v8, a130
    v_accvgpr_read_b32 v9, a131
    s_nop 0
    v_mul_f32 v6, v6, v5
    v_mul_f32 v7, v7, v5
    v_mul_f32 v8, v8, v5
    v_mul_f32 v9, v9, v5
    s_nop 0
    v_accvgpr_write_b32 a128, v6
    v_accvgpr_write_b32 a129, v7
    v_accvgpr_write_b32 a130, v8
    v_accvgpr_write_b32 a131, v9
    s_nop 0
    v_accvgpr_read_b32 v6, a132
    v_accvgpr_read_b32 v7, a133
    v_accvgpr_read_b32 v8, a134
    v_accvgpr_read_b32 v9, a135
    s_nop 0
    v_mul_f32 v6, v6, v5
    v_mul_f32 v7, v7, v5
    v_mul_f32 v8, v8, v5
    v_mul_f32 v9, v9, v5
    s_nop 0
    v_accvgpr_write_b32 a132, v6
    v_accvgpr_write_b32 a133, v7
    v_accvgpr_write_b32 a134, v8
    v_accvgpr_write_b32 a135, v9
    s_nop 0
    v_accvgpr_read_b32 v6, a136
    v_accvgpr_read_b32 v7, a137
    v_accvgpr_read_b32 v8, a138
    v_accvgpr_read_b32 v9, a139
    s_nop 0
    v_mul_f32 v6, v6, v5
    v_mul_f32 v7, v7, v5
    v_mul_f32 v8, v8, v5
    v_mul_f32 v9, v9, v5
    s_nop 0
    v_accvgpr_write_b32 a136, v6
    v_accvgpr_write_b32 a137, v7
    v_accvgpr_write_b32 a138, v8
    v_accvgpr_write_b32 a139, v9
    s_nop 0
    v_accvgpr_read_b32 v6, a140
    v_accvgpr_read_b32 v7, a141
    v_accvgpr_read_b32 v8, a142
    v_accvgpr_read_b32 v9, a143
    s_nop 0
    v_mul_f32 v6, v6, v5
    v_mul_f32 v7, v7, v5
    v_mul_f32 v8, v8, v5
    v_mul_f32 v9, v9, v5
    s_nop 0
    v_accvgpr_write_b32 a140, v6
    v_accvgpr_write_b32 a141, v7
    v_accvgpr_write_b32 a142, v8
    v_accvgpr_write_b32 a143, v9
    s_nop 0
    v_accvgpr_read_b32 v6, a144
    v_accvgpr_read_b32 v7, a145
    v_accvgpr_read_b32 v8, a146
    v_accvgpr_read_b32 v9, a147
    s_nop 0
    v_mul_f32 v6, v6, v5
    v_mul_f32 v7, v7, v5
    v_mul_f32 v8, v8, v5
    v_mul_f32 v9, v9, v5
    s_nop 0
    v_accvgpr_write_b32 a144, v6
    v_accvgpr_write_b32 a145, v7
    v_accvgpr_write_b32 a146, v8
    v_accvgpr_write_b32 a147, v9
    s_nop 0
    v_accvgpr_read_b32 v6, a148
    v_accvgpr_read_b32 v7, a149
    v_accvgpr_read_b32 v8, a150
    v_accvgpr_read_b32 v9, a151
    s_nop 0
    v_mul_f32 v6, v6, v5
    v_mul_f32 v7, v7, v5
    v_mul_f32 v8, v8, v5
    v_mul_f32 v9, v9, v5
    s_nop 0
    v_accvgpr_write_b32 a148, v6
    v_accvgpr_write_b32 a149, v7
    v_accvgpr_write_b32 a150, v8
    v_accvgpr_write_b32 a151, v9
    s_nop 0
    v_accvgpr_read_b32 v6, a152
    v_accvgpr_read_b32 v7, a153
    v_accvgpr_read_b32 v8, a154
    v_accvgpr_read_b32 v9, a155
    s_nop 0
    v_mul_f32 v6, v6, v5
    v_mul_f32 v7, v7, v5
    v_mul_f32 v8, v8, v5
    v_mul_f32 v9, v9, v5
    s_nop 0
    v_accvgpr_write_b32 a152, v6
    v_accvgpr_write_b32 a153, v7
    v_accvgpr_write_b32 a154, v8
    v_accvgpr_write_b32 a155, v9
    s_nop 0
    v_accvgpr_read_b32 v6, a156
    v_accvgpr_read_b32 v7, a157
    v_accvgpr_read_b32 v8, a158
    v_accvgpr_read_b32 v9, a159
    s_nop 0
    v_mul_f32 v6, v6, v5
    v_mul_f32 v7, v7, v5
    v_mul_f32 v8, v8, v5
    v_mul_f32 v9, v9, v5
    s_nop 0
    v_accvgpr_write_b32 a156, v6
    v_accvgpr_write_b32 a157, v7
    v_accvgpr_write_b32 a158, v8
    v_accvgpr_write_b32 a159, v9
    s_nop 0
    v_mul_f32 v84, v84, v5
    v_mul_f32 v85, v85, v5
    v_mul_f32 v86, v86, v5
    v_mul_f32 v87, v87, v5
    s_nop 1
    s_branch RET_7_4
.section .rodata,"a"
.p2align 6
.amdhsa_kernel standalone__gqa_softmax__near_ridge_kernel
  .amdhsa_next_free_vgpr 496
  .amdhsa_next_free_sgpr 80
  .amdhsa_accum_offset 256
  .amdhsa_group_segment_fixed_size 0
  .amdhsa_kernarg_size 48
  .amdhsa_user_sgpr_count 2
  .amdhsa_user_sgpr_kernarg_segment_ptr 1
  .amdhsa_system_sgpr_workgroup_id_x 1
.end_amdhsa_kernel
```
